```python
import torch

def _softmax(x, axis=-1):
    return torch.softmax(x, dim=axis)
def _gelu(x):
    return torch.nn.functional.gelu(x, approximate="tanh")
def _silu(x):
    return torch.nn.functional.silu(x)
def _sigmoid(x):
    return torch.sigmoid(x)
def _layernorm(x, axis=-1, eps=1e-5):
    m = x.mean(dim=axis, keepdim=True)
    v = x.var(dim=axis, keepdim=True, unbiased=False)
    return (x - m) / torch.sqrt(v + eps)
def _scatter_add(tgt, idx, src, axis=0):
    return tgt.clone().index_add_(axis, idx, src)
def _segment_sum(src, seg, n):
    out = torch.zeros((n,) + src.shape[1:], dtype=src.dtype)
    return out.index_add_(0, seg, src)
def _pad(x, pw):
    flat = tuple(v for pair in reversed(pw) for v in pair)
    return torch.nn.functional.pad(x, flat)

kernel_name = 'interleave_layers__sliding_block_cached__glu_gated_glu__decode'

def setup_inputs():

    _w = (lambda a: (lambda t: t.to(torch.bfloat16) if t.is_floating_point() else t)(torch.as_tensor(a)))
    def _A_setup():
        B, Sq, D = 1, 1, 512
        Hq, Hkv, Sk, Dh = 32, 8, 32768, 128
        assert Hq % Hkv == 0, (Hq, Hkv)
        return {
            "x": _w((lambda *s: torch.randn(*s, dtype=torch.bfloat16) * 0.05)(B, Sq, D)),
            "k_cache": _w((lambda *s: torch.randn(*s, dtype=torch.bfloat16) * 1.6)(B, Hkv, Sk, Dh)),
            "v_cache": _w((lambda *s: torch.randn(*s, dtype=torch.bfloat16) * 1.6)(B, Hkv, Sk, Dh)),
            "wq": _w((lambda *s: torch.randn(*s, dtype=torch.bfloat16) * 1.6)(D, Hq * Dh) * (D ** -0.5)),
            "wo": _w((lambda *s: torch.randn(*s, dtype=torch.bfloat16) * 1.6)(Hq * Dh, D) * ((Hq * Dh) ** -0.5)),
        }
    _A_in = _A_setup()

    def _B_setup():
        B, S, D, F = 1, 1, 512, 1792
        return {
            "x": _w((lambda *s: torch.randn(*s, dtype=torch.bfloat16) * 0.05)(B, S, D)),
            "w_gate": _w((lambda *s: torch.randn(*s, dtype=torch.bfloat16) * 0.05)(D, F)),
            "w_up": _w((lambda *s: torch.randn(*s, dtype=torch.bfloat16) * 0.05)(D, F)),
            "w_down": _w((lambda *s: torch.randn(*s, dtype=torch.bfloat16) * 0.05)(F, D)),
        }
    _B_in = _B_setup()

    return {
        "A_x": _A_in["x"],
        "A_k_cache": _A_in["k_cache"],
        "A_v_cache": _A_in["v_cache"],
        "A_wq": _A_in["wq"],
        "A_wo": _A_in["wo"],
        "B_x": _B_in["x"],
        "B_w_gate": _B_in["w_gate"],
        "B_w_up": _B_in["w_up"],
        "B_w_down": _B_in["w_down"],
    }

def reference(A_x, A_k_cache, A_v_cache, A_wq, A_wo, B_x, B_w_gate, B_w_up, B_w_down):
    def _A_ref(x, k_cache, v_cache, wq, wo):
        B, Sq, D = x.shape
        Hq, Dh = 32, 128
        Hkv, Sk = k_cache.shape[1], k_cache.shape[2]
        W = min(4096, max(256, Sk // 4))
        rep = Hq // Hkv
        q = (lambda x, *d: x.permute(*d))((x @ wq).reshape(B, Sq, Hq, Dh), 0, 2, 1, 3)
        k = (lambda x, n, axis: torch.repeat_interleave(x, n, dim=axis))(k_cache[:, :, Sk - W:, :], rep, axis=1)
        v = (lambda x, n, axis: torch.repeat_interleave(x, n, dim=axis))(v_cache[:, :, Sk - W:, :], rep, axis=1)
        scores = torch.einsum("bhqd,bhkd->bhqk", q, k) * (Dh ** -0.5)
        p = _softmax(scores, axis=-1)
        o = torch.einsum("bhqk,bhkd->bhqd", p, v)
        return (lambda x, *d: x.permute(*d))(o, 0, 2, 1, 3).reshape(B, Sq, Hq * Dh) @ wo

    def _B_ref(x, w_gate, w_up, w_down):
        g = torch.einsum("bsd,df->bsf", x, w_gate)
        u = torch.einsum("bsd,df->bsf", x, w_up)
        h = _sigmoid(g) * u
        return torch.einsum("bsf,fd->bsd", h, w_down)

    x = A_x
    x = x + _A_ref(_layernorm(x, axis=-1), A_k_cache, A_v_cache, A_wq, A_wo)
    x = x + _B_ref(_layernorm(x, axis=-1), B_w_gate, B_w_up, B_w_down)
    x = x + _A_ref(_layernorm(x, axis=-1), A_k_cache, A_v_cache, A_wq, A_wo)
    x = x + _B_ref(_layernorm(x, axis=-1), B_w_gate, B_w_up, B_w_down)
    return x
```

```asm
; @launch grid=(256,1,1) block=(512,1,1) lds=86016
.amdgcn_target "amdgcn-amd-amdhsa--gfx950"
.text
.globl interleave_layers__sliding_block_cached__glu_gated_glu__decode_kernel
.p2align 8
.type interleave_layers__sliding_block_cached__glu_gated_glu__decode_kernel,@function
interleave_layers__sliding_block_cached__glu_gated_glu__decode_kernel:
    s_cmp_ge_u32 s2, 256
    s_cbranch_scc1 L_end
    s_load_dwordx16 s[16:31], s[0:1], 0
    s_load_dwordx8 s[32:39], s[0:1], 64
    s_getpc_b64 s[66:67]
L_vpf:
    v_lshlrev_b32_e64 v2, 7, v0
    v_cmp_gt_u32 vcc, (L_code_end-L_vpf-4)/128+1, v0
    s_cmp_lt_u32 s2, 16
    s_cselect_b64 exec, vcc, 0
    global_load_dword v255, v2, s[66:67]
    s_mov_b64 exec, -1
    s_getreg_b32 s4, hwreg(HW_REG_XCC_ID)
    s_and_b32 s4, s4, 7
    s_lshr_b32 s5, s2, 3
    s_xor_b32 s6, s4, 0
    s_mov_b32 s7, 0
    s_movk_i32 s3, 0x3000
    v_lshrrev_b32 v1, 6, v0
    v_and_b32 v0, 63, v0
    v_readfirstlane_b32 s8, v1
    v_mov_b32 v31, 0
L_restart:
    s_lshl_b32 s9, s6, 5
    s_add_u32 s9, s9, s5
    s_cmp_lt_u32 s8, 4
    s_cbranch_scc1 L_roleA
    s_cmp_eq_u32 s8, 4
    s_cbranch_scc1 L_roleL
    s_cmp_eq_u32 s8, 5
    s_cbranch_scc1 L_roleO
    s_cmp_eq_u32 s8, 6
    s_cbranch_scc1 L_roleR
    s_branch L_roleD
L_roleA:
    v_mov_b32 v8, 0
    v_mov_b32 v9, 0
    v_mov_b32 v10, 0
    v_mov_b32 v11, 0
    ds_write_b128 v31, v[8:11] offset:3584
    ds_write_b128 v31, v[8:11] offset:3600
    ds_write_b128 v31, v[8:11] offset:3616
    ds_write_b128 v31, v[8:11] offset:3632
    ds_write_b128 v31, v[8:11] offset:3648
    v_lshrrev_b32_e64 v1, 4, v0
    v_and_b32 v2, 15, v0
    s_lshl_b32 s10, s6, 23
    s_lshl_b32 s11, s5, 15
    s_add_u32 s10, s10, s11
    s_lshl_b32 s11, s8, 13
    s_add_u32 s10, s10, s11
    s_add_u32 s11, s10, 0x700000
    s_add_u32 s12, s11, 4096
    v_lshlrev_b32 v4, 1, v1
    v_xor_b32 v4, v4, v2
    v_lshlrev_b32_e64 v4, 4, v4
    v_lshl_add_u32 v4, v1, 8, v4
    v_xor_b32 v5, 0x80, v4
    s_lshl_b32 s13, s8, 1
    s_add_u32 s13, s13, s5
    s_add_u32 s14, s13, 0
    s_and_b32 s14, s14, 7
    s_lshl_b32 s52, s14, 10
    s_add_u32 s14, s13, 1
    s_and_b32 s14, s14, 7
    s_lshl_b32 s53, s14, 10
    s_add_u32 s14, s13, 2
    s_and_b32 s14, s14, 7
    s_lshl_b32 s54, s14, 10
    s_add_u32 s14, s13, 3
    s_and_b32 s14, s14, 7
    s_lshl_b32 s55, s14, 10
    s_add_u32 s14, s13, 4
    s_and_b32 s14, s14, 7
    s_lshl_b32 s56, s14, 10
    s_add_u32 s14, s13, 5
    s_and_b32 s14, s14, 7
    s_lshl_b32 s57, s14, 10
    s_add_u32 s14, s13, 6
    s_and_b32 s14, s14, 7
    s_lshl_b32 s58, s14, 10
    s_add_u32 s14, s13, 7
    s_and_b32 s14, s14, 7
    s_lshl_b32 s59, s14, 10
    s_lshr_b32 s14, s52, 3
    s_and_b32 s14, s14, 0x80
    v_xor_b32 v4, s14, v4
    v_xor_b32 v5, s14, v5
    v_xor_b32 v3, v1, v2
    v_lshlrev_b32 v3, 4, v3
    v_lshl_add_u32 v32, v1, 8, v3
    s_lshr_b32 s14, s53, 4
    s_and_b32 s14, s14, 0xc0
    v_xor_b32 v33, s14, v32
    s_lshr_b32 s14, s54, 4
    s_and_b32 s14, s14, 0xc0
    v_xor_b32 v34, s14, v32
    s_lshr_b32 s14, s55, 4
    s_and_b32 s14, s14, 0xc0
    v_xor_b32 v35, s14, v32
    s_lshr_b32 s14, s52, 4
    s_and_b32 s14, s14, 0xc0
    v_xor_b32_e64 v32, s14, v32
    s_lshl_b32 s15, s8, 13
    s_waitcnt lgkmcnt(0)
    s_waitcnt lgkmcnt(0)
    s_mov_b32 s40, s38
    s_and_b32 s41, s39, 0xffff
    s_mov_b32 s42, 0x10000000
    s_mov_b32 s43, 0x20000
    s_mov_b32 s44, s18
    s_and_b32 s45, s19, 0xffff
    s_mov_b32 s46, 0x4000000
    s_mov_b32 s47, 0x20000
    s_mov_b32 s48, s20
    s_and_b32 s49, s21, 0xffff
    s_mov_b32 s50, 0x4000000
    s_mov_b32 s51, 0x20000
    s_barrier
    s_barrier
    s_barrier
    s_add_u32 s14, s15, s52
    s_add_u32 m0, s14, 53248
    s_add_u32 s12, s11, s52
    buffer_load_dwordx4 v32, s[44:47], s12 offen nt lds
    s_add_u32 s14, s15, s53
    s_add_u32 m0, s14, 53248
    s_add_u32 s12, s11, s53
    buffer_load_dwordx4 v33, s[44:47], s12 offen nt lds
    v_and_b32 v7, 3, v0
    v_bfe_u32 v8, v0, 2, 2
    v_lshlrev_b32_e64 v9, 4, v7
    v_lshl_add_u32 v9, v1, 6, v9
    v_add_u32 v20, 1024, v9
    v_and_b32_e64 v9, 1, v1
    v_lshl_add_u32 v9, v9, 2, v8
    v_lshlrev_b32 v9, 1, v9
    v_lshrrev_b32 v10, 1, v7
    s_lshl_b32 s13, s8, 2
    v_add_u32 v10, s13, v10
    v_lshl_add_u32 v11, v1, 2, v8
    v_lshlrev_b32 v11, 8, v11
    v_and_b32 v12, 1, v7
    v_lshl_add_u32 v11, v12, 3, v11
    v_xor_b32_e64 v12, v10, v9
    v_lshl_add_u32 v22, v12, 4, v11
    v_add_u32 v10, 2, v10
    v_xor_b32 v12, v10, v9
    v_lshl_add_u32 v23, v12, 4, v11
    v_lshl_add_u32 v9, v1, 2, v7
    v_lshlrev_b32_e64 v9, 4, v9
    v_add_u32 v25, 2048, v9
    s_lshl_b32 s13, s8, 8
    v_add_u32 v9, s13, v25
    v_and_b32 v10, 1, v8
    v_lshlrev_b32 v10, 1, v10
    v_lshrrev_b32 v11, 1, v8
    v_add_u32 v10, v10, v11
    v_lshl_add_u32 v24, v10, 2, v9
    v_lshlrev_b32 v27, 4, v7
    v_add_u32 v27, 3072, v27
    s_lshl_b32 s13, s8, 2
    v_add_u32 v26, s13, v27
    s_lshl_b32 s13, s9, 11
    s_add_u32 s14, s8, s5
    s_lshl_b32 s14, s14, 7
    v_lshl_add_u32 v28, v2, 9, s14
    v_and_b32 v28, 0x7ff, v28
    s_add_u32 s13, s13, 0x100000
    v_lshl_add_u32 v28, v1, 4, v28
    v_add_u32 v28, s13, v28
    s_lshl_b32 s13, s6, 13
    s_lshl_b32 s14, s8, 8
    s_add_u32 s13, s13, s14
    s_add_u32 s13, s13, 0x20000
    v_lshlrev_b32_e64 v180, 11, v1
    v_lshl_add_u32 v180, v2, 4, v180
    v_add_u32 v180, s13, v180
    s_lshl_b32 s14, s8, 4
    s_add_u32 s14, s14, 1024
    v_lshl_add_u32 v181, v8, 8, s14
    v_lshl_add_u32 v181, v7, 6, v181
    v_lshrrev_b32 v9, 1, v1
    v_lshl_add_u32 v181, v9, 3, v181
    v_and_b32 v9, 1, v1
    v_lshl_add_u32 v181, v9, 2, v181
    s_mov_b32 s74, 0x3db504f3
    s_mov_b32 s75, 0x3fb8aa3b
    s_mov_b32 s76, 0xffff0000
    s_mov_b32 s70, 0xff00ff00
    s_mov_b32 s71, 0xff00ff00
    s_mov_b32 s72, 0xf0f0f0f0
    s_mov_b32 s73, 0xf0f0f0f0
    ds_read_b32 v30, v31 offset:3656
    s_add_u32 s14, s15, s54
    s_add_u32 m0, s14, 53248
    s_add_u32 s12, s11, s54
    s_waitcnt vmcnt(1) lgkmcnt(0)
    v_readfirstlane_b32 s10, v30
    s_nop 0
    s_cmp_lg_u32 s10, 0
    s_cbranch_scc1 L_a_open2
    buffer_load_dwordx4 v34, s[44:47], s12 offen nt lds
    s_add_u32 s14, s15, s55
    s_add_u32 m0, s14, 53248
    s_add_u32 s12, s11, s55
    buffer_load_dwordx4 v35, s[44:47], s12 offen nt lds
    s_add_u32 s14, s15, s56
    s_add_u32 m0, s14, 53248
    s_add_u32 s12, s11, s56
    buffer_load_dwordx4 v32, s[44:47], s12 offen nt lds
    s_add_u32 s14, s15, s57
    s_add_u32 m0, s14, 53248
    s_add_u32 s12, s11, s57
    buffer_load_dwordx4 v33, s[44:47], s12 offen nt lds
    ds_read_b32 v30, v31 offset:3656
    s_add_u32 s14, s15, s58
    s_add_u32 m0, s14, 53248
    s_add_u32 s12, s11, s58
    s_waitcnt vmcnt(5) lgkmcnt(0)
    v_readfirstlane_b32 s10, v30
    s_nop 0
    s_cmp_lg_u32 s10, 0
    s_cbranch_scc1 L_a_open6
    buffer_load_dwordx4 v34, s[44:47], s12 offen nt lds
    ds_read_b32 v30, v31 offset:3656
    s_add_u32 s14, s15, s59
    s_add_u32 m0, s14, 53248
    s_add_u32 s12, s11, s59
    s_waitcnt vmcnt(5) lgkmcnt(0)
    v_readfirstlane_b32 s10, v30
    s_nop 0
    s_cmp_lg_u32 s10, 0
    s_cbranch_scc1 L_a_open7
    buffer_load_dwordx4 v35, s[44:47], s12 offen nt lds
    ds_read_b32 v30, v31 offset:3656
    s_add_u32 s14, s15, s52
    s_add_u32 m0, s14, 4096
    s_add_u32 s12, s11, s52
    s_waitcnt vmcnt(5) lgkmcnt(0)
    v_readfirstlane_b32 s10, v30
    s_nop 0
    s_cmp_lg_u32 s10, 0
    s_cbranch_scc1 L_a_open8
    buffer_load_dwordx4 v4, s[48:51], s12 offen nt lds
    ds_read_b32 v30, v31 offset:3656
    s_add_u32 s14, s15, s53
    s_add_u32 m0, s14, 4096
    s_add_u32 s12, s11, s53
    s_waitcnt vmcnt(5) lgkmcnt(0)
    v_readfirstlane_b32 s10, v30
    s_nop 0
    s_cmp_lg_u32 s10, 0
    s_cbranch_scc1 L_a_open9
    buffer_load_dwordx4 v5, s[48:51], s12 offen nt lds
    ds_read_b32 v30, v31 offset:3656
    s_add_u32 s14, s15, s54
    s_add_u32 m0, s14, 4096
    s_add_u32 s12, s11, s54
    s_waitcnt vmcnt(5) lgkmcnt(0)
    v_readfirstlane_b32 s10, v30
    s_nop 0
    s_cmp_lg_u32 s10, 0
    s_cbranch_scc1 L_a_open10
    buffer_load_dwordx4 v4, s[48:51], s12 offen nt lds
    ds_read_b32 v30, v31 offset:3656
    s_add_u32 s14, s15, s55
    s_add_u32 m0, s14, 4096
    s_add_u32 s12, s11, s55
    s_waitcnt vmcnt(5) lgkmcnt(0)
    v_readfirstlane_b32 s10, v30
    s_nop 0
    s_cmp_lg_u32 s10, 0
    s_cbranch_scc1 L_a_open11
    buffer_load_dwordx4 v5, s[48:51], s12 offen nt lds
    ds_read_b32 v30, v31 offset:3656
    s_add_u32 s14, s15, s56
    s_add_u32 m0, s14, 4096
    s_add_u32 s12, s11, s56
    s_waitcnt vmcnt(5) lgkmcnt(0)
    v_readfirstlane_b32 s10, v30
    s_nop 0
    s_cmp_lg_u32 s10, 0
    s_cbranch_scc1 L_a_open12
    buffer_load_dwordx4 v4, s[48:51], s12 offen nt lds
    ds_read_b32 v30, v31 offset:3656
    s_add_u32 s14, s15, s57
    s_add_u32 m0, s14, 4096
    s_add_u32 s12, s11, s57
    s_waitcnt vmcnt(5) lgkmcnt(0)
    v_readfirstlane_b32 s10, v30
    s_nop 0
    s_cmp_lg_u32 s10, 0
    s_cbranch_scc1 L_a_open13
    buffer_load_dwordx4 v5, s[48:51], s12 offen nt lds
    ds_read_b32 v30, v31 offset:3656
    s_add_u32 s14, s15, s58
    s_add_u32 m0, s14, 4096
    s_add_u32 s12, s11, s58
    s_waitcnt vmcnt(5) lgkmcnt(0)
    v_readfirstlane_b32 s10, v30
    s_nop 0
    s_cmp_lg_u32 s10, 0
    s_cbranch_scc1 L_a_open14
    buffer_load_dwordx4 v4, s[48:51], s12 offen nt lds
    ds_read_b32 v30, v31 offset:3656
    s_add_u32 s14, s15, s59
    s_add_u32 m0, s14, 4096
    s_add_u32 s12, s11, s59
    s_waitcnt vmcnt(5) lgkmcnt(0)
    v_readfirstlane_b32 s10, v30
    s_nop 0
    s_cmp_lg_u32 s10, 0
    s_cbranch_scc1 L_a_open15
    buffer_load_dwordx4 v5, s[48:51], s12 offen nt lds
    s_branch L_a_issued
    s_nop 0
L_a_open2:
    s_add_u32 s14, s15, s54
    s_add_u32 m0, s14, 53248
    s_add_u32 s12, s11, s54
    buffer_load_dwordx4 v34, s[44:47], s12 offen nt lds
    s_add_u32 s14, s15, s55
    s_add_u32 m0, s14, 53248
    s_add_u32 s12, s11, s55
    buffer_load_dwordx4 v35, s[44:47], s12 offen nt lds
    s_add_u32 s14, s15, s56
    s_add_u32 m0, s14, 53248
    s_add_u32 s12, s11, s56
    buffer_load_dwordx4 v32, s[44:47], s12 offen nt lds
    s_add_u32 s14, s15, s57
    s_add_u32 m0, s14, 53248
    s_add_u32 s12, s11, s57
    buffer_load_dwordx4 v33, s[44:47], s12 offen nt lds
L_a_open6:
    s_add_u32 s14, s15, s58
    s_add_u32 m0, s14, 53248
    s_add_u32 s12, s11, s58
    buffer_load_dwordx4 v34, s[44:47], s12 offen nt lds
L_a_open7:
    s_add_u32 s14, s15, s59
    s_add_u32 m0, s14, 53248
    s_add_u32 s12, s11, s59
    buffer_load_dwordx4 v35, s[44:47], s12 offen nt lds
L_a_open8:
    s_add_u32 s14, s15, s52
    s_add_u32 m0, s14, 4096
    s_add_u32 s12, s11, s52
    buffer_load_dwordx4 v4, s[48:51], s12 offen nt lds
L_a_open9:
    s_add_u32 s14, s15, s53
    s_add_u32 m0, s14, 4096
    s_add_u32 s12, s11, s53
    buffer_load_dwordx4 v5, s[48:51], s12 offen nt lds
L_a_open10:
    s_add_u32 s14, s15, s54
    s_add_u32 m0, s14, 4096
    s_add_u32 s12, s11, s54
    buffer_load_dwordx4 v4, s[48:51], s12 offen nt lds
L_a_open11:
    s_add_u32 s14, s15, s55
    s_add_u32 m0, s14, 4096
    s_add_u32 s12, s11, s55
    buffer_load_dwordx4 v5, s[48:51], s12 offen nt lds
L_a_open12:
    s_add_u32 s14, s15, s56
    s_add_u32 m0, s14, 4096
    s_add_u32 s12, s11, s56
    buffer_load_dwordx4 v4, s[48:51], s12 offen nt lds
L_a_open13:
    s_add_u32 s14, s15, s57
    s_add_u32 m0, s14, 4096
    s_add_u32 s12, s11, s57
    buffer_load_dwordx4 v5, s[48:51], s12 offen nt lds
L_a_open14:
    s_add_u32 s14, s15, s58
    s_add_u32 m0, s14, 4096
    s_add_u32 s12, s11, s58
    buffer_load_dwordx4 v4, s[48:51], s12 offen nt lds
L_a_open15:
    s_add_u32 s14, s15, s59
    s_add_u32 m0, s14, 4096
    s_add_u32 s12, s11, s59
    buffer_load_dwordx4 v5, s[48:51], s12 offen nt lds
L_a_issued:
    s_lshl_b32 s13, s8, 2
    v_mov_b32 v8, s13
    v_mov_b32 v30, 1
    ds_write_b32 v8, v30 offset:3632
    v_lshl_add_u32 v8, v2, 8, v3
    s_add_u32 s13, s15, 53248
    v_add_u32_e64 v8, s13, v8
    v_xor_b32 v9, 64, v8
    v_xor_b32 v10, 128, v8
    v_xor_b32 v11, 192, v8
    s_waitcnt vmcnt(8)
    ds_read_b128 v[32:35], v8 offset:0
    ds_read_b128 v[36:39], v9 offset:0
    ds_read_b128 v[40:43], v10 offset:0
    ds_read_b128 v[44:47], v11 offset:0
    ds_read_b128 v[48:51], v8 offset:4096
    ds_read_b128 v[52:55], v9 offset:4096
    ds_read_b128 v[56:59], v10 offset:4096
    ds_read_b128 v[60:63], v11 offset:4096
    s_waitcnt lgkmcnt(0)
    s_barrier
    ds_read_b128 v[96:99], v20 offset:0
    ds_read_b32 v30, v31 offset:3584
    ds_read_b128 v[100:103], v20 offset:256
    ds_read_b128 v[104:107], v20 offset:512
    ds_read_b128 v[108:111], v20 offset:768
    s_waitcnt lgkmcnt(4)
    v_mfma_f32_16x16x32_bf16 v[112:115], v[32:35], v[96:99], 0
    v_mfma_f32_16x16x32_bf16 v[116:119], v[48:51], v[96:99], 0
    s_waitcnt lgkmcnt(2)
    v_mfma_f32_16x16x32_bf16 v[112:115], v[36:39], v[100:103], v[112:115]
    v_readfirstlane_b32 s10, v30
    v_mfma_f32_16x16x32_bf16 v[116:119], v[52:55], v[100:103], v[116:119]
    s_waitcnt lgkmcnt(1)
    v_mfma_f32_16x16x32_bf16 v[112:115], v[40:43], v[104:107], v[112:115]
    s_cmp_eq_u32 s10, 0
    s_cbranch_scc0 L_fallback
    v_mfma_f32_16x16x32_bf16 v[116:119], v[56:59], v[104:107], v[116:119]
    s_waitcnt lgkmcnt(0)
    v_mfma_f32_16x16x32_bf16 v[112:115], v[44:47], v[108:111], v[112:115]
    v_mfma_f32_16x16x32_bf16 v[116:119], v[60:63], v[108:111], v[116:119]
    s_nop 6
    v_cndmask_b32 v112, v112, v114, s[70:71]
    v_cndmask_b32 v113, v113, v115, s[70:71]
    v_cndmask_b32 v116, v116, v118, s[70:71]
    v_cndmask_b32 v117, v117, v119, s[70:71]
    v_cndmask_b32 v112, v112, v116, s[72:73]
    v_cndmask_b32 v113, v113, v117, s[72:73]
    v_cvt_pk_bf16_f32 v10, 0, v112
    v_cvt_pk_bf16_f32 v11, 0, v113
    v_pk_mul_f32 v[10:11], v[10:11], s[74:75] op_sel_hi:[1,0]
    v_cvt_pk_bf16_f32 v10, 0, v10
    v_cvt_pk_bf16_f32 v11, 0, v11
    v_max_f32 v14, v10, v11
    s_nop 1
    v_max_f32_dpp v14, v14, v14 row_ror:4 row_mask:0xf bank_mask:0xf
    s_nop 1
    v_max_f32_dpp v14, v14, v14 row_ror:8 row_mask:0xf bank_mask:0xf
    v_mov_b32 v13, v14
    s_nop 1
    v_permlane16_swap_b32 v14, v13
    v_max_f32 v14, v14, v13
    v_mov_b32 v13, v14
    s_nop 1
    v_permlane32_swap_b32 v14, v13
    v_max_f32 v14, v14, v13
    v_mul_f32 v14, s75, v14
    v_pk_fma_f32 v[10:11], v[10:11], s[74:75], v[14:15] op_sel:[0,1,0] op_sel_hi:[1,1,0] neg_lo:[0,0,1] neg_hi:[0,0,1]
    v_exp_f32 v11, v11
    v_exp_f32 v10, v10
    ds_write_b32 v26, v14
    v_cvt_pk_bf16_f32 v10, v10, v11
    ds_write_b32 v24, v10
    s_waitcnt vmcnt(0) lgkmcnt(0)
    s_barrier
    ds_read_b128 v[8:11], v27
    ds_read_b128 v[132:135], v25 offset:0
    ds_read_b64_tr_b16 v[64:65], v22 offset:4096
    ds_read_b64_tr_b16 v[66:67], v22 offset:8192
    ds_read_b64_tr_b16 v[80:81], v23 offset:4096
    ds_read_b64_tr_b16 v[82:83], v23 offset:8192
    ds_read_b128 v[136:139], v25 offset:256
    ds_read_b64_tr_b16 v[68:69], v22 offset:12288
    ds_read_b64_tr_b16 v[70:71], v22 offset:16384
    ds_read_b64_tr_b16 v[84:85], v23 offset:12288
    ds_read_b64_tr_b16 v[86:87], v23 offset:16384
    ds_read_b128 v[140:143], v25 offset:512
    ds_read_b64_tr_b16 v[72:73], v22 offset:20480
    ds_read_b64_tr_b16 v[74:75], v22 offset:24576
    ds_read_b64_tr_b16 v[88:89], v23 offset:20480
    ds_read_b64_tr_b16 v[90:91], v23 offset:24576
    ds_read_b128 v[144:147], v25 offset:768
    ds_read_b64_tr_b16 v[76:77], v22 offset:28672
    ds_read_b64_tr_b16 v[78:79], v22 offset:32768
    ds_read_b64_tr_b16 v[92:93], v23 offset:28672
    ds_read_b64_tr_b16 v[94:95], v23 offset:32768
    s_waitcnt lgkmcnt(15)
    v_mfma_f32_16x16x32_bf16 v[148:151], v[64:67], v[132:135], 0
    v_max_f32 v16, v8, v9
    v_max3_f32 v16, v16, v10, v11
    v_mfma_f32_16x16x32_bf16 v[164:167], v[80:83], v[132:135], 0
    v_sub_f32_e64 v8, v8, v16
    v_sub_f32 v9, v9, v16
    s_waitcnt lgkmcnt(10)
    v_mfma_f32_16x16x32_bf16 v[152:155], v[68:71], v[136:139], 0
    v_exp_f32 v8, v8
    v_sub_f32 v10, v10, v16
    v_mfma_f32_16x16x32_bf16 v[168:171], v[84:87], v[136:139], 0
    v_exp_f32_e64 v9, v9
    v_sub_f32 v11, v11, v16
    s_waitcnt lgkmcnt(5)
    v_mfma_f32_16x16x32_bf16 v[156:159], v[72:75], v[140:143], 0
    v_exp_f32 v10, v10
    v_mul_f32 v148, v8, v148
    v_mfma_f32_16x16x32_bf16 v[172:175], v[88:91], v[140:143], 0
    v_exp_f32_e64 v11, v11
    v_mul_f32 v149, v8, v149
    s_waitcnt lgkmcnt(0)
    v_mfma_f32_16x16x32_bf16 v[160:163], v[76:79], v[144:147], 0
    v_mul_f32 v150, v8, v150
    v_mul_f32 v151, v8, v151
    v_mfma_f32_16x16x32_bf16 v[176:179], v[92:95], v[144:147], 0
    v_mul_f32 v164, v8, v164
    v_mul_f32 v165, v8, v165
    v_mul_f32 v166, v8, v166
    v_mul_f32 v167, v8, v167
    s_mov_b32 exec_lo, 0x000f000f
    s_mov_b32 exec_hi, 0x000f000f
    s_cmp_lg_u32 s7, 0
    v_pk_fma_f32 v[148:149], v[8:9], v[152:153], v[148:149] op_sel:[1,0,0] op_sel_hi:[1,1,1]
    v_pk_fma_f32 v[150:151], v[8:9], v[154:155], v[150:151] op_sel:[1,0,0] op_sel_hi:[1,1,1]
    v_pk_fma_f32 v[148:149], v[10:11], v[156:157], v[148:149] op_sel:[0,0,0] op_sel_hi:[0,1,1]
    v_pk_fma_f32 v[150:151], v[10:11], v[158:159], v[150:151] op_sel:[0,0,0] op_sel_hi:[0,1,1]
    v_pk_fma_f32 v[148:149], v[10:11], v[160:161], v[148:149] op_sel:[1,0,0] op_sel_hi:[1,1,1]
    v_pk_fma_f32 v[150:151], v[10:11], v[162:163], v[150:151] op_sel:[1,0,0] op_sel_hi:[1,1,1]
    v_and_or_b32 v148, v148, -16, 14
    s_cbranch_scc1 L_slow_1
    buffer_store_dwordx4 v[148:151], v28, s[40:43], s7 offen offset:0
    v_pk_fma_f32 v[164:165], v[8:9], v[168:169], v[164:165] op_sel:[1,0,0] op_sel_hi:[1,1,1]
    v_pk_fma_f32 v[166:167], v[8:9], v[170:171], v[166:167] op_sel:[1,0,0] op_sel_hi:[1,1,1]
    v_pk_fma_f32 v[164:165], v[10:11], v[172:173], v[164:165] op_sel:[0,0,0] op_sel_hi:[0,1,1]
    v_pk_fma_f32 v[166:167], v[10:11], v[174:175], v[166:167] op_sel:[0,0,0] op_sel_hi:[0,1,1]
    v_pk_fma_f32 v[164:165], v[10:11], v[176:177], v[164:165] op_sel:[1,0,0] op_sel_hi:[1,1,1]
    v_pk_fma_f32 v[166:167], v[10:11], v[178:179], v[166:167] op_sel:[1,0,0] op_sel_hi:[1,1,1]
    v_and_or_b32 v164, v164, -16, 14
    buffer_store_dwordx4 v[164:167], v28, s[40:43], s7 offen offset:64
L_pub_2:
    s_mov_b64 exec, -1
    v_bfe_u32 v8, v0, 2, 2
    v_lshl_add_u32 v9, v1, 3, v8
    v_lshlrev_b32 v9, 7, v9
    v_and_b32_e64 v10, 1, v0
    v_lshl_add_u32 v9, v10, 3, v9
    v_bfe_u32 v10, v0, 1, 1
    v_lshl_add_u32 v9, v10, 4, v9
    v_xor_b32_e64 v10, s8, v8
    v_lshl_add_u32 v9, v10, 5, v9
    ds_read_b64_tr_b16 v[208:209], v9 offset:36864
    ds_read_b64_tr_b16 v[210:211], v9 offset:37376
    ds_read_b64_tr_b16 v[212:213], v9 offset:40960
    ds_read_b64_tr_b16 v[214:215], v9 offset:41472
    ds_read_b64_tr_b16 v[216:217], v9 offset:45056
    ds_read_b64_tr_b16 v[218:219], v9 offset:45568
    ds_read_b64_tr_b16 v[220:221], v9 offset:49152
    ds_read_b64_tr_b16 v[222:223], v9 offset:49664
    v_mov_b32 v228, 0x3f803f80
    v_mov_b32 v229, 0x3f803f80
    v_mov_b32 v230, 0x3f803f80
    v_mov_b32 v231, 0x3f803f80
    s_and_b32 s13, s5, 3
    s_lshl_b32 s14, s6, 10
    s_add_u32 s14, s14, 0x4000
    v_lshl_add_u32 v182, v0, 4, s14
    s_lshl_b32 s12, s13, 8
    s_add_u32 s14, s14, s12
    v_lshl_add_u32 v183, v1, 4, s14
    v_lshlrev_b32_e64 v182, 4, v0
    v_lshl_add_u32 v183, v1, 4, s12
    s_lshl_b32 s12, s6, 13
    s_lshl_b32 s13, s13, 11
    s_add_u32 s12, s12, s13
    s_lshr_b32 s13, s5, 2
    s_lshl_b32 s13, s13, 7
    s_add_u32 s12, s12, s13
    s_lshl_b32 s13, s8, 5
    s_add_u32 s12, s12, s13
    s_add_u32 s12, s12, 0x20000
    v_and_b32_e64 v8, 1, v1
    v_lshl_add_u32 v29, v8, 10, s12
    v_lshrrev_b32 v8, 1, v1
    v_lshl_add_u32 v29, v8, 4, v29
    s_mov_b32 s77, 0x3f803f80
    s_waitcnt lgkmcnt(0)
    v_mfma_f32_16x16x32_bf16 v[224:227], v[208:211], v[228:231], 0
    v_mfma_f32_16x16x32_bf16 v[224:227], v[212:215], v[228:231], v[224:227]
    v_mfma_f32_16x16x32_bf16 v[224:227], v[216:219], v[228:231], v[224:227]
    v_mfma_f32_16x16x32_bf16 v[224:227], v[220:223], v[228:231], v[224:227]
    v_mov_b32 v16, 0
    v_mov_b32 v17, 0
    v_mov_b32 v8, 0x10000000
    v_and_b32_e64 v9, 15, v0
    v_cmp_eq_u32 vcc, 0, v9
    s_nop 1
    v_cndmask_b32 v29, v8, v29, vcc
    s_barrier
    ds_read_b128 v[244:247], v182 offset:0
    ds_read_b32 v30, v31 offset:3584
    ds_read_b128 v[228:231], v183 offset:0
    ds_read_b128 v[232:235], v183 offset:64
    ds_read_b128 v[236:239], v183 offset:128
    ds_read_b128 v[240:243], v183 offset:192
    s_waitcnt lgkmcnt(5)
    v_dot2c_f32_bf16 v16, s77, v244
    v_dot2c_f32_bf16 v17, v244, v244
    v_dot2c_f32_bf16 v16, s77, v245
    v_dot2c_f32_bf16 v17, v245, v245
    v_dot2c_f32_bf16 v16, s77, v246
    v_dot2c_f32_bf16 v17, v246, v246
    v_dot2c_f32_bf16 v16, s77, v247
    v_dot2c_f32_bf16 v17, v247, v247
    s_waitcnt lgkmcnt(3)
    v_readfirstlane_b32 s10, v30
    v_mfma_f32_16x16x32_bf16 v[248:251], v[208:211], v[228:231], 0
    v_permlane32_swap_b32 v16, v17
    v_add_f32 v16, v16, v17
    s_waitcnt lgkmcnt(2)
    v_mfma_f32_16x16x32_bf16 v[248:251], v[212:215], v[232:235], v[248:251]
    v_add_f32_dpp v16, v16, v16 quad_perm:[1,0,3,2] row_mask:0xf bank_mask:0xf
    s_cmp_eq_u32 s10, 0
    s_cbranch_scc0 L_a_bq2
    v_add_f32_dpp v16, v16, v16 quad_perm:[2,3,0,1] row_mask:0xf bank_mask:0xf
    s_waitcnt lgkmcnt(1)
    v_mfma_f32_16x16x32_bf16 v[248:251], v[216:219], v[236:239], v[248:251]
    v_add_f32_dpp v16, v16, v16 row_half_mirror row_mask:0xf bank_mask:0xf
    s_cmp_lg_u32 s7, 0
    s_waitcnt lgkmcnt(0)
    v_add_f32_dpp v16, v16, v16 row_mirror row_mask:0xf bank_mask:0xf
    v_mov_b32 v17, v16
    v_mfma_f32_16x16x32_bf16 v[248:251], v[220:223], v[240:243], v[248:251]
    s_nop 0
    v_permlane16_swap_b32 v16, v17
    v_add_f32_e64 v16, v16, v17
    v_mul_f32 v16, 0x3b000000, v16
    v_mov_b32 v18, v16
    s_nop 1
    v_permlane32_swap_b32 v16, v18
    v_fma_f32 v18, -v16, v16, v18
    v_max_f32 v18, 0, v18
    v_cvt_pk_bf16_f32 v18, 0, v18
    v_cvt_pk_bf16_f32 v16, 0, v16
    v_add_f32 v18, 0x3727c5ac, v18
    v_cvt_pk_bf16_f32 v18, 0, v18
    v_sqrt_f32_e64 v18, v18
    v_pk_fma_f32 v[248:249], v[16:17], v[224:225], v[248:249] op_sel:[0,0,0] op_sel_hi:[0,1,1] neg_lo:[1,0,0] neg_hi:[1,0,0]
    v_cvt_pk_bf16_f32 v18, 0, v18
    v_rcp_f32_e64 v18, v18
    v_pk_fma_f32 v[250:251], v[16:17], v[226:227], v[250:251] op_sel:[0,0,0] op_sel_hi:[0,1,1] neg_lo:[1,0,0] neg_hi:[1,0,0]
    v_pk_mul_f32 v[248:249], v[18:19], v[248:249] op_sel:[0,0] op_sel_hi:[0,1]
    v_pk_mul_f32 v[250:251], v[18:19], v[250:251] op_sel:[0,0] op_sel_hi:[0,1]
    v_and_or_b32 v248, v248, -16, 12
    s_cbranch_scc1 L_slow_3
    buffer_store_dwordx4 v[248:251], v29, s[40:43], s7 offen
L_pub_4:
    s_mov_b32 s65, 0
    s_nop 15
    s_nop 15
    s_nop 0
    s_nop 15
    buffer_load_dwordx4 v[184:187], v180, s[40:43], s7 offen offset:0 sc1
    buffer_load_dwordx4 v[188:191], v180, s[40:43], s7 offen offset:1024 sc1
    s_nop 0
    s_nop 15
    s_nop 15
    s_nop 15
L_gp_5:
    buffer_load_dwordx4 v[192:195], v180, s[40:43], s7 offen offset:0 sc1
    buffer_load_dwordx4 v[196:199], v180, s[40:43], s7 offen offset:1024 sc1
    s_add_u32 s65, s65, 1
    s_cmp_lt_u32 s65, s3
    s_cbranch_scc0 L_gz_9
    s_waitcnt vmcnt(2)
    v_bitop3_b32 v10, v184, v188, 2 bitop3:0xa8
    v_cmp_ne_u32 vcc, 0, v10
    v_permlane32_swap_b32 v184, v188
    v_permlane32_swap_b32 v185, v189
    v_permlane32_swap_b32 v186, v190
    v_permlane32_swap_b32 v187, v191
    v_add_f32 v184, v184, v188
    v_add_f32 v185, v185, v189
    v_add_f32 v186, v186, v190
    v_add_f32 v187, v187, v191
    s_nop 0
    v_permlane16_swap_b32 v184, v186
    v_permlane16_swap_b32 v185, v187
    v_add_f32 v8, v184, v186
    v_add_f32 v9, v185, v187
    v_cvt_pk_bf16_f32 v8, v8, v9
    ds_write_b32 v181, v8
    s_cbranch_vccz L_gd_6
    buffer_load_dwordx4 v[184:187], v180, s[40:43], s7 offen offset:0 sc1
    buffer_load_dwordx4 v[188:191], v180, s[40:43], s7 offen offset:1024 sc1
    s_waitcnt vmcnt(2)
    v_bitop3_b32 v10, v192, v196, 2 bitop3:0xa8
    v_cmp_ne_u32 vcc, 0, v10
    v_permlane32_swap_b32 v192, v196
    v_permlane32_swap_b32 v193, v197
    v_permlane32_swap_b32 v194, v198
    v_permlane32_swap_b32 v195, v199
    v_add_f32 v192, v192, v196
    v_add_f32 v193, v193, v197
    v_add_f32 v194, v194, v198
    v_add_f32 v195, v195, v199
    s_nop 0
    v_permlane16_swap_b32 v192, v194
    v_permlane16_swap_b32 v193, v195
    v_add_f32_e64 v8, v192, v194
    v_add_f32 v9, v193, v195
    v_cvt_pk_bf16_f32 v8, v8, v9
    ds_write_b32 v181, v8
    s_cbranch_vccnz L_gp_5
L_gz_9:
L_gd_6:
    s_waitcnt lgkmcnt(0)
L_a_bq2:
    s_barrier
    ds_read_b128 v[96:99], v20 offset:0
    ds_read_b32 v30, v31 offset:3584
    ds_read_b128 v[100:103], v20 offset:256
    ds_read_b128 v[104:107], v20 offset:512
    ds_read_b128 v[108:111], v20 offset:768
    s_waitcnt lgkmcnt(4)
    v_mfma_f32_16x16x32_bf16 v[112:115], v[32:35], v[96:99], 0
    v_mfma_f32_16x16x32_bf16 v[116:119], v[48:51], v[96:99], 0
    s_waitcnt lgkmcnt(2)
    v_mfma_f32_16x16x32_bf16 v[112:115], v[36:39], v[100:103], v[112:115]
    v_readfirstlane_b32 s10, v30
    v_mfma_f32_16x16x32_bf16 v[116:119], v[52:55], v[100:103], v[116:119]
    s_waitcnt lgkmcnt(1)
    v_mfma_f32_16x16x32_bf16 v[112:115], v[40:43], v[104:107], v[112:115]
    s_cmp_eq_u32 s10, 0
    s_cbranch_scc0 L_fallback
    v_mfma_f32_16x16x32_bf16 v[116:119], v[56:59], v[104:107], v[116:119]
    s_waitcnt lgkmcnt(0)
    v_mfma_f32_16x16x32_bf16 v[112:115], v[44:47], v[108:111], v[112:115]
    v_mfma_f32_16x16x32_bf16 v[116:119], v[60:63], v[108:111], v[116:119]
    s_nop 6
    v_cndmask_b32 v112, v112, v114, s[70:71]
    v_cndmask_b32 v113, v113, v115, s[70:71]
    v_cndmask_b32 v116, v116, v118, s[70:71]
    v_cndmask_b32 v117, v117, v119, s[70:71]
    v_cndmask_b32 v112, v112, v116, s[72:73]
    v_cndmask_b32 v113, v113, v117, s[72:73]
    v_cvt_pk_bf16_f32 v10, 0, v112
    v_cvt_pk_bf16_f32 v11, 0, v113
    v_pk_mul_f32 v[10:11], v[10:11], s[74:75] op_sel_hi:[1,0]
    v_cvt_pk_bf16_f32 v10, 0, v10
    v_cvt_pk_bf16_f32 v11, 0, v11
    v_max_f32 v14, v10, v11
    s_nop 1
    v_max_f32_dpp v14, v14, v14 row_ror:4 row_mask:0xf bank_mask:0xf
    s_nop 1
    v_max_f32_dpp v14, v14, v14 row_ror:8 row_mask:0xf bank_mask:0xf
    v_mov_b32 v13, v14
    s_nop 1
    v_permlane16_swap_b32 v14, v13
    v_max_f32 v14, v14, v13
    v_mov_b32 v13, v14
    s_nop 1
    v_permlane32_swap_b32 v14, v13
    v_max_f32 v14, v14, v13
    v_mul_f32 v14, s75, v14
    v_pk_fma_f32 v[10:11], v[10:11], s[74:75], v[14:15] op_sel:[0,1,0] op_sel_hi:[1,1,0] neg_lo:[0,0,1] neg_hi:[0,0,1]
    v_exp_f32 v11, v11
    v_exp_f32 v10, v10
    ds_write_b32 v26, v14
    v_cvt_pk_bf16_f32 v10, v10, v11
    ds_write_b32 v24, v10
    s_waitcnt lgkmcnt(0)
    s_barrier
    ds_read_b128 v[8:11], v27
    ds_read_b128 v[132:135], v25 offset:0
    ds_read_b128 v[136:139], v25 offset:256
    ds_read_b128 v[140:143], v25 offset:512
    ds_read_b128 v[144:147], v25 offset:768
    s_waitcnt lgkmcnt(3)
    v_mfma_f32_16x16x32_bf16 v[148:151], v[64:67], v[132:135], 0
    v_max_f32 v16, v8, v9
    v_max3_f32 v16, v16, v10, v11
    v_mfma_f32_16x16x32_bf16 v[164:167], v[80:83], v[132:135], 0
    v_sub_f32_e64 v8, v8, v16
    v_sub_f32 v9, v9, v16
    s_waitcnt lgkmcnt(2)
    v_mfma_f32_16x16x32_bf16 v[152:155], v[68:71], v[136:139], 0
    v_exp_f32 v8, v8
    v_sub_f32 v10, v10, v16
    v_mfma_f32_16x16x32_bf16 v[168:171], v[84:87], v[136:139], 0
    v_exp_f32_e64 v9, v9
    v_sub_f32 v11, v11, v16
    s_waitcnt lgkmcnt(1)
    v_mfma_f32_16x16x32_bf16 v[156:159], v[72:75], v[140:143], 0
    v_exp_f32 v10, v10
    v_mul_f32 v148, v8, v148
    v_mfma_f32_16x16x32_bf16 v[172:175], v[88:91], v[140:143], 0
    v_exp_f32_e64 v11, v11
    v_mul_f32 v149, v8, v149
    s_waitcnt lgkmcnt(0)
    v_mfma_f32_16x16x32_bf16 v[160:163], v[76:79], v[144:147], 0
    v_mul_f32 v150, v8, v150
    v_mul_f32 v151, v8, v151
    v_mfma_f32_16x16x32_bf16 v[176:179], v[92:95], v[144:147], 0
    v_mul_f32 v164, v8, v164
    v_mul_f32 v165, v8, v165
    v_mul_f32 v166, v8, v166
    v_mul_f32 v167, v8, v167
    s_mov_b32 exec_lo, 0x000f000f
    s_mov_b32 exec_hi, 0x000f000f
    s_cmp_lg_u32 s7, 0
    v_pk_fma_f32 v[148:149], v[8:9], v[152:153], v[148:149] op_sel:[1,0,0] op_sel_hi:[1,1,1]
    v_pk_fma_f32 v[150:151], v[8:9], v[154:155], v[150:151] op_sel:[1,0,0] op_sel_hi:[1,1,1]
    v_pk_fma_f32 v[148:149], v[10:11], v[156:157], v[148:149] op_sel:[0,0,0] op_sel_hi:[0,1,1]
    v_pk_fma_f32 v[150:151], v[10:11], v[158:159], v[150:151] op_sel:[0,0,0] op_sel_hi:[0,1,1]
    v_pk_fma_f32 v[148:149], v[10:11], v[160:161], v[148:149] op_sel:[1,0,0] op_sel_hi:[1,1,1]
    v_pk_fma_f32 v[150:151], v[10:11], v[162:163], v[150:151] op_sel:[1,0,0] op_sel_hi:[1,1,1]
    v_and_or_b32 v148, v148, -16, 8
    s_cbranch_scc1 L_slow_10
    buffer_store_dwordx4 v[148:151], v28, s[40:43], s7 offen offset:0
    v_pk_fma_f32 v[164:165], v[8:9], v[168:169], v[164:165] op_sel:[1,0,0] op_sel_hi:[1,1,1]
    v_pk_fma_f32 v[166:167], v[8:9], v[170:171], v[166:167] op_sel:[1,0,0] op_sel_hi:[1,1,1]
    v_pk_fma_f32 v[164:165], v[10:11], v[172:173], v[164:165] op_sel:[0,0,0] op_sel_hi:[0,1,1]
    v_pk_fma_f32 v[166:167], v[10:11], v[174:175], v[166:167] op_sel:[0,0,0] op_sel_hi:[0,1,1]
    v_pk_fma_f32 v[164:165], v[10:11], v[176:177], v[164:165] op_sel:[1,0,0] op_sel_hi:[1,1,1]
    v_pk_fma_f32 v[166:167], v[10:11], v[178:179], v[166:167] op_sel:[1,0,0] op_sel_hi:[1,1,1]
    v_and_or_b32 v164, v164, -16, 8
    buffer_store_dwordx4 v[164:167], v28, s[40:43], s7 offen offset:64
L_pub_11:
    s_mov_b64 exec, -1
    s_endpgm
    s_nop 0
L_slow_1:
    s_nop 4
    buffer_store_dwordx4 v[148:151], v28, s[40:43], s7 offen offset:0 sc1
    v_pk_fma_f32 v[164:165], v[8:9], v[168:169], v[164:165] op_sel:[1,0,0] op_sel_hi:[1,1,1]
    v_pk_fma_f32 v[166:167], v[8:9], v[170:171], v[166:167] op_sel:[1,0,0] op_sel_hi:[1,1,1]
    v_pk_fma_f32 v[164:165], v[10:11], v[172:173], v[164:165] op_sel:[0,0,0] op_sel_hi:[0,1,1]
    v_pk_fma_f32 v[166:167], v[10:11], v[174:175], v[166:167] op_sel:[0,0,0] op_sel_hi:[0,1,1]
    v_pk_fma_f32 v[164:165], v[10:11], v[176:177], v[164:165] op_sel:[1,0,0] op_sel_hi:[1,1,1]
    v_pk_fma_f32 v[166:167], v[10:11], v[178:179], v[166:167] op_sel:[1,0,0] op_sel_hi:[1,1,1]
    v_and_or_b32 v164, v164, -16, 14
    buffer_store_dwordx4 v[164:167], v28, s[40:43], s7 offen offset:64 sc1
    s_branch L_pub_2
L_slow_3:
    s_nop 4
    buffer_store_dwordx4 v[248:251], v29, s[40:43], s7 offen sc1
    s_branch L_pub_4
L_slow_10:
    s_nop 4
    buffer_store_dwordx4 v[148:151], v28, s[40:43], s7 offen offset:0 sc1
    v_pk_fma_f32 v[164:165], v[8:9], v[168:169], v[164:165] op_sel:[1,0,0] op_sel_hi:[1,1,1]
    v_pk_fma_f32 v[166:167], v[8:9], v[170:171], v[166:167] op_sel:[1,0,0] op_sel_hi:[1,1,1]
    v_pk_fma_f32 v[164:165], v[10:11], v[172:173], v[164:165] op_sel:[0,0,0] op_sel_hi:[0,1,1]
    v_pk_fma_f32 v[166:167], v[10:11], v[174:175], v[166:167] op_sel:[0,0,0] op_sel_hi:[0,1,1]
    v_pk_fma_f32 v[164:165], v[10:11], v[176:177], v[164:165] op_sel:[1,0,0] op_sel_hi:[1,1,1]
    v_pk_fma_f32 v[166:167], v[10:11], v[178:179], v[166:167] op_sel:[1,0,0] op_sel_hi:[1,1,1]
    v_and_or_b32 v164, v164, -16, 8
    buffer_store_dwordx4 v[164:167], v28, s[40:43], s7 offen offset:64 sc1
    s_branch L_pub_11
L_roleL:
    s_setprio 3
    s_memtime s[74:75]
    v_lshlrev_b32_e64 v2, 4, v0
    v_lshrrev_b32 v1, 3, v0
    v_and_b32 v3, 3, v1
    v_lshlrev_b32 v3, 1, v3
    v_and_b32 v4, 7, v0
    v_xor_b32 v3, v3, v4
    v_lshlrev_b32 v3, 4, v3
    v_lshl_add_u32 v1, v1, 13, v3
    s_and_b32 s15, s5, 3
    s_lshl_b32 s10, s15, 20
    s_lshl_b32 s11, s6, 10
    s_add_u32 s10, s10, s11
    s_lshr_b32 s11, s5, 2
    s_lshl_b32 s12, s11, 7
    s_add_u32 s10, s10, s12
    s_mov_b32 s12, s10
    s_waitcnt lgkmcnt(0)
    s_mov_b32 s40, s38
    s_and_b32 s41, s39, 0xffff
    s_mov_b32 s42, 0x10000000
    s_mov_b32 s43, 0x20000
    s_mov_b32 s44, s22
    s_and_b32 s45, s23, 0xffff
    s_mov_b32 s46, 0x400000
    s_mov_b32 s47, 0x20000
    s_mov_b32 s48, s16
    s_and_b32 s49, s17, 0xffff
    s_mov_b32 s50, 0x400
    s_mov_b32 s51, 0x20000
    s_mov_b32 s52, s36
    s_and_b32 s53, s37, 0xffff
    s_mov_b32 s54, 0x100
    s_mov_b32 s55, 0x20000
    s_barrier
    s_barrier
    buffer_load_dwordx4 v[4:7], v2, s[48:51], 0 offen
    s_mov_b32 m0, 36864
    s_nop 0
    buffer_load_dwordx4 v1, s[44:47], s10 offen nt lds
    s_add_u32 s10, s10, 0x10000
    s_mov_b32 m0, 37888
    s_nop 0
    buffer_load_dwordx4 v1, s[44:47], s10 offen nt lds
    s_add_u32 s10, s10, 0x10000
    s_mov_b32 m0, 38912
    s_nop 0
    buffer_load_dwordx4 v1, s[44:47], s10 offen nt lds
    s_add_u32 s10, s10, 0x10000
    s_mov_b32 m0, 39936
    s_nop 0
    buffer_load_dwordx4 v1, s[44:47], s10 offen nt lds
    s_add_u32 s10, s10, 0x10000
    s_mov_b32 m0, 40960
    s_nop 0
    buffer_load_dwordx4 v1, s[44:47], s10 offen nt lds
    s_add_u32 s10, s10, 0x10000
    s_mov_b32 m0, 41984
    s_nop 0
    buffer_load_dwordx4 v1, s[44:47], s10 offen nt lds
    s_add_u32 s10, s10, 0x10000
    s_mov_b32 m0, 43008
    s_nop 0
    buffer_load_dwordx4 v1, s[44:47], s10 offen nt lds
    s_add_u32 s10, s10, 0x10000
    s_mov_b32 m0, 44032
    s_nop 0
    buffer_load_dwordx4 v1, s[44:47], s10 offen nt lds
    s_add_u32 s10, s10, 0x10000
    s_mov_b32 m0, 45056
    s_nop 0
    buffer_load_dwordx4 v1, s[44:47], s10 offen nt lds
    s_add_u32 s10, s10, 0x10000
    s_mov_b32 m0, 46080
    s_nop 0
    buffer_load_dwordx4 v1, s[44:47], s10 offen nt lds
    s_add_u32 s10, s10, 0x10000
    s_mov_b32 m0, 47104
    s_nop 0
    buffer_load_dwordx4 v1, s[44:47], s10 offen nt lds
    s_add_u32 s10, s10, 0x10000
    s_mov_b32 m0, 48128
    s_nop 0
    buffer_load_dwordx4 v1, s[44:47], s10 offen nt lds
    s_add_u32 s10, s10, 0x10000
    s_mov_b32 m0, 49152
    s_nop 0
    buffer_load_dwordx4 v1, s[44:47], s10 offen nt lds
    s_add_u32 s10, s10, 0x10000
    s_mov_b32 m0, 50176
    s_nop 0
    buffer_load_dwordx4 v1, s[44:47], s10 offen nt lds
    s_add_u32 s10, s10, 0x10000
    s_mov_b32 m0, 51200
    s_nop 0
    buffer_load_dwordx4 v1, s[44:47], s10 offen nt lds
    s_add_u32 s10, s10, 0x10000
    s_mov_b32 m0, 52224
    s_nop 0
    buffer_load_dwordx4 v1, s[44:47], s10 offen nt lds
    s_barrier
    s_mov_b32 s76, 0xffff0000
    v_lshrrev_b32 v1, 4, v0
    v_and_b32 v3, 15, v0
    s_lshl_b32 s14, s15, 8
    s_add_u32 s14, s14, 0
    v_lshl_add_u32 v32, v1, 4, s14
    v_cmp_eq_u32 vcc, 0, v3
    s_nop 1
    v_cndmask_b32 v52, 0, -16, vcc
    v_cmp_eq_u32 vcc, 1, v3
    s_nop 1
    v_cndmask_b32 v53, 0, -16, vcc
    v_cmp_eq_u32 vcc, 2, v3
    s_nop 1
    v_cndmask_b32 v54, 0, -16, vcc
    v_cmp_eq_u32 vcc, 3, v3
    s_nop 1
    v_cndmask_b32 v55, 0, -16, vcc
    v_bfe_u32 v8, v0, 2, 2
    v_lshlrev_b32 v33, 8, v8
    v_and_b32 v9, 3, v0
    v_lshl_add_u32 v33, v9, 6, v33
    v_lshl_add_u32 v33, v1, 4, v33
    v_lshl_add_u32 v34, v1, 2, v9
    v_lshlrev_b32_e64 v34, 4, v34
    v_lshlrev_b32 v35, 4, v9
    s_lshl_b32 s13, s6, 11
    s_and_b32 s14, s5, 15
    s_lshl_b32 s14, s14, 4
    s_add_u32 s13, s13, s14
    s_lshr_b32 s14, s5, 4
    s_lshl_b32 s14, s14, 3
    s_add_u32 s13, s13, s14
    s_add_u32 s13, s13, 0x8000
    v_lshl_add_u32 v29, v9, 8, s13
    v_bfe_u32 v8, v0, 2, 2
    v_lshl_add_u32 v9, v1, 3, v8
    v_lshlrev_b32 v9, 7, v9
    v_and_b32 v10, 1, v0
    v_lshl_add_u32 v9, v10, 3, v9
    v_bfe_u32 v10, v0, 1, 1
    v_lshl_add_u32 v9, v10, 4, v9
    v_xor_b32_e64 v10, 0, v8
    v_lshl_add_u32 v36, v10, 5, v9
    v_xor_b32 v10, 1, v8
    v_lshl_add_u32 v37, v10, 5, v9
    v_xor_b32 v10, 2, v8
    v_lshl_add_u32 v38, v10, 5, v9
    v_xor_b32 v10, 3, v8
    v_lshl_add_u32 v39, v10, 5, v9
    s_lshl_b32 s71, s6, 13
    s_lshl_b32 s12, s15, 11
    s_add_u32 s12, s12, s71
    s_lshl_b32 s13, s11, 7
    s_add_u32 s12, s12, s13
    s_add_u32 s12, s12, 0x20000
    s_add_u32 s71, s71, 0x20000
    v_and_b32 v8, 1, v1
    v_lshl_add_u32 v28, v8, 10, s12
    v_lshrrev_b32 v8, 1, v1
    v_lshl_add_u32 v8, v3, 1, v8
    v_lshl_add_u32 v28, v8, 4, v28
    s_lshl_b32 s70, s6, 10
    s_add_u32 s72, s70, s5
    v_lshl_add_u32 v40, v1, 2, v3
    v_lshl_add_u32 v40, v40, 6, s72
    s_add_u32 s72, s70, 0x10000
    s_add_u32 s70, s70, 0x4000
    s_add_u32 s77, s70, s7
    s_waitcnt vmcnt(16)
    v_lshlrev_b32 v8, 16, v4
    v_and_b32 v9, s76, v4
    v_lshlrev_b32 v10, 16, v5
    v_and_b32 v11, s76, v5
    v_lshlrev_b32 v12, 16, v6
    v_and_b32 v13, s76, v6
    v_lshlrev_b32 v14, 16, v7
    v_and_b32 v15, s76, v7
    v_add_f32 v16, v8, v9
    v_mul_f32 v17, v8, v8
    v_fmac_f32 v17, v9, v9
    v_add_f32 v16, v16, v10
    v_fmac_f32 v17, v10, v10
    v_add_f32 v16, v16, v11
    v_fmac_f32 v17, v11, v11
    v_add_f32 v16, v16, v12
    v_fmac_f32 v17, v12, v12
    v_add_f32 v16, v16, v13
    v_fmac_f32 v17, v13, v13
    v_add_f32 v16, v16, v14
    v_fmac_f32 v17, v14, v14
    v_add_f32 v16, v16, v15
    v_fmac_f32 v17, v15, v15
    s_nop 0
    v_add_f32_dpp v16, v16, v16 quad_perm:[1,0,3,2] row_mask:0xf bank_mask:0xf
    v_add_f32_dpp v17, v17, v17 quad_perm:[1,0,3,2] row_mask:0xf bank_mask:0xf
    s_nop 0
    v_add_f32_dpp v16, v16, v16 quad_perm:[2,3,0,1] row_mask:0xf bank_mask:0xf
    v_add_f32_dpp v17, v17, v17 quad_perm:[2,3,0,1] row_mask:0xf bank_mask:0xf
    s_nop 0
    v_add_f32_dpp v16, v16, v16 row_half_mirror row_mask:0xf bank_mask:0xf
    v_add_f32_dpp v17, v17, v17 row_half_mirror row_mask:0xf bank_mask:0xf
    s_nop 0
    v_add_f32_dpp v16, v16, v16 row_mirror row_mask:0xf bank_mask:0xf
    v_add_f32_dpp v17, v17, v17 row_mirror row_mask:0xf bank_mask:0xf
    v_mov_b32 v18, v16
    v_mov_b32 v19, v17
    s_nop 0
    v_permlane16_swap_b32 v16, v18
    v_permlane16_swap_b32 v17, v19
    v_add_f32 v16, v16, v18
    v_add_f32 v17, v17, v19
    v_mov_b32 v18, v16
    v_mov_b32 v19, v17
    s_nop 0
    v_permlane32_swap_b32 v16, v18
    v_permlane32_swap_b32 v17, v19
    v_add_f32 v16, v16, v18
    v_add_f32_e64 v17, v17, v19
    v_mul_f32 v16, 0x3b000000, v16
    v_mul_f32 v17, 0x3b000000, v17
    v_fma_f32 v17, -v16, v16, v17
    v_max_f32_e64 v17, 0, v17
    v_cvt_pk_bf16_f32 v16, v16, v17
    v_and_b32 v17, s76, v16
    v_lshlrev_b32 v16, 16, v16
    v_add_f32 v17, 0x3727c5ac, v17
    v_cvt_pk_bf16_f32 v17, v17, v17
    v_and_b32 v17, s76, v17
    v_sqrt_f32 v17, v17
    v_sub_f32 v8, v8, v16
    v_sub_f32 v9, v9, v16
    v_sub_f32 v10, v10, v16
    v_sub_f32 v11, v11, v16
    v_sub_f32 v12, v12, v16
    v_sub_f32 v13, v13, v16
    v_sub_f32 v14, v14, v16
    v_sub_f32 v15, v15, v16
    v_cvt_pk_bf16_f32 v17, v17, v17
    v_and_b32 v17, s76, v17
    v_rcp_f32 v17, v17
    v_cvt_pk_bf16_f32 v20, v8, v9
    v_cvt_pk_bf16_f32 v21, v10, v11
    v_cvt_pk_bf16_f32 v22, v12, v13
    v_cvt_pk_bf16_f32 v23, v14, v15
    v_lshlrev_b32 v8, 16, v20
    v_and_b32 v9, s76, v20
    v_lshlrev_b32 v10, 16, v21
    v_and_b32 v11, s76, v21
    v_lshlrev_b32 v12, 16, v22
    v_and_b32 v13, s76, v22
    v_lshlrev_b32 v14, 16, v23
    v_and_b32 v15, s76, v23
    v_mul_f32 v8, v8, v17
    v_mul_f32 v9, v9, v17
    v_mul_f32 v10, v10, v17
    v_mul_f32 v11, v11, v17
    v_mul_f32 v12, v12, v17
    v_mul_f32 v13, v13, v17
    v_mul_f32 v14, v14, v17
    v_mul_f32 v15, v15, v17
    v_cvt_pk_bf16_f32 v20, v8, v9
    v_cvt_pk_bf16_f32 v21, v10, v11
    v_cvt_pk_bf16_f32 v22, v12, v13
    v_cvt_pk_bf16_f32 v23, v14, v15
    ds_write_b128 v2, v[20:23] offset:0
    ds_read_b128 v[192:195], v32 offset:0
    ds_read_b128 v[196:199], v32 offset:64
    ds_read_b128 v[200:203], v32 offset:128
    ds_read_b128 v[204:207], v32 offset:192
    s_waitcnt lgkmcnt(0)
    s_waitcnt vmcnt(12)
    ds_read_b64_tr_b16 v[64:65], v36 offset:36864
    ds_read_b64_tr_b16 v[66:67], v36 offset:37376
    ds_read_b64_tr_b16 v[68:69], v37 offset:36864
    ds_read_b64_tr_b16 v[70:71], v37 offset:37376
    ds_read_b64_tr_b16 v[72:73], v38 offset:36864
    ds_read_b64_tr_b16 v[74:75], v38 offset:37376
    ds_read_b64_tr_b16 v[76:77], v39 offset:36864
    ds_read_b64_tr_b16 v[78:79], v39 offset:37376
    s_waitcnt vmcnt(8)
    ds_read_b64_tr_b16 v[80:81], v36 offset:40960
    ds_read_b64_tr_b16 v[82:83], v36 offset:41472
    ds_read_b64_tr_b16 v[84:85], v37 offset:40960
    ds_read_b64_tr_b16 v[86:87], v37 offset:41472
    ds_read_b64_tr_b16 v[88:89], v38 offset:40960
    ds_read_b64_tr_b16 v[90:91], v38 offset:41472
    ds_read_b64_tr_b16 v[92:93], v39 offset:40960
    ds_read_b64_tr_b16 v[94:95], v39 offset:41472
    s_waitcnt lgkmcnt(14)
    v_mfma_f32_16x16x32_bf16 v[208:211], v[64:67], v[192:195], 0
    s_waitcnt lgkmcnt(12)
    v_mfma_f32_16x16x32_bf16 v[212:215], v[68:71], v[192:195], 0
    s_waitcnt lgkmcnt(10)
    v_mfma_f32_16x16x32_bf16 v[216:219], v[72:75], v[192:195], 0
    s_waitcnt lgkmcnt(8)
    v_mfma_f32_16x16x32_bf16 v[220:223], v[76:79], v[192:195], 0
    s_waitcnt vmcnt(4)
    ds_read_b64_tr_b16 v[96:97], v36 offset:45056
    ds_read_b64_tr_b16 v[98:99], v36 offset:45568
    ds_read_b64_tr_b16 v[100:101], v37 offset:45056
    ds_read_b64_tr_b16 v[102:103], v37 offset:45568
    ds_read_b64_tr_b16 v[104:105], v38 offset:45056
    ds_read_b64_tr_b16 v[106:107], v38 offset:45568
    ds_read_b64_tr_b16 v[108:109], v39 offset:45056
    ds_read_b64_tr_b16 v[110:111], v39 offset:45568
    s_waitcnt lgkmcnt(14)
    v_mfma_f32_16x16x32_bf16 v[208:211], v[80:83], v[196:199], v[208:211]
    s_waitcnt lgkmcnt(12)
    v_mfma_f32_16x16x32_bf16 v[212:215], v[84:87], v[196:199], v[212:215]
    s_waitcnt lgkmcnt(10)
    v_mfma_f32_16x16x32_bf16 v[216:219], v[88:91], v[196:199], v[216:219]
    s_waitcnt lgkmcnt(8)
    v_mfma_f32_16x16x32_bf16 v[220:223], v[92:95], v[196:199], v[220:223]
    s_waitcnt vmcnt(0)
    ds_read_b64_tr_b16 v[112:113], v36 offset:49152
    ds_read_b64_tr_b16 v[114:115], v36 offset:49664
    ds_read_b64_tr_b16 v[116:117], v37 offset:49152
    ds_read_b64_tr_b16 v[118:119], v37 offset:49664
    ds_read_b64_tr_b16 v[120:121], v38 offset:49152
    ds_read_b64_tr_b16 v[122:123], v38 offset:49664
    ds_read_b64_tr_b16 v[124:125], v39 offset:49152
    ds_read_b64_tr_b16 v[126:127], v39 offset:49664
    s_waitcnt lgkmcnt(14)
    v_mfma_f32_16x16x32_bf16 v[208:211], v[96:99], v[200:203], v[208:211]
    s_waitcnt lgkmcnt(12)
    v_mfma_f32_16x16x32_bf16 v[212:215], v[100:103], v[200:203], v[212:215]
    s_waitcnt lgkmcnt(10)
    v_mfma_f32_16x16x32_bf16 v[216:219], v[104:107], v[200:203], v[216:219]
    s_waitcnt lgkmcnt(8)
    v_mfma_f32_16x16x32_bf16 v[220:223], v[108:111], v[200:203], v[220:223]
    s_waitcnt lgkmcnt(6)
    v_mfma_f32_16x16x32_bf16 v[208:211], v[112:115], v[204:207], v[208:211]
    s_waitcnt lgkmcnt(4)
    v_mfma_f32_16x16x32_bf16 v[212:215], v[116:119], v[204:207], v[212:215]
    s_waitcnt lgkmcnt(2)
    v_mfma_f32_16x16x32_bf16 v[216:219], v[120:123], v[204:207], v[216:219]
    s_waitcnt lgkmcnt(0)
    v_mfma_f32_16x16x32_bf16 v[220:223], v[124:127], v[204:207], v[220:223]
    s_nop 1
    v_and_or_b32 v24, v208, v52, 14
    v_and_or_b32 v25, v209, v52, 14
    v_and_or_b32 v26, v210, v52, 14
    v_and_or_b32 v27, v211, v52, 14
    v_and_or_b32 v24, v212, v53, v24
    v_and_or_b32 v25, v213, v53, v25
    v_and_or_b32 v26, v214, v53, v26
    v_and_or_b32 v27, v215, v53, v27
    v_and_or_b32 v24, v216, v54, v24
    v_and_or_b32 v25, v217, v54, v25
    v_and_or_b32 v26, v218, v54, v26
    v_and_or_b32 v27, v219, v54, v27
    v_and_or_b32 v24, v220, v55, v24
    v_and_or_b32 v25, v221, v55, v25
    v_and_or_b32 v26, v222, v55, v26
    v_and_or_b32 v27, v223, v55, v27
    s_cmp_eq_u32 s5, 0
    s_cbranch_scc1 L_notlead_12
    s_mov_b64 exec, 1
    v_mov_b32 v30, 1
    ds_write_b32 v31, v30 offset:3616
    s_mov_b64 exec, -1
L_notlead_12:
L_wa_13:
    ds_read_b128 v[8:11], v31 offset:3616
    s_waitcnt lgkmcnt(0)
    v_min_u32 v8, v8, v9
    v_min3_u32 v8, v8, v10, v11
    s_nop 0
    v_readfirstlane_b32 s10, v8
    s_nop 0
    s_cmp_lg_u32 s10, 0
    s_cbranch_scc0 L_wad_14
    s_mov_b32 s73, 0x10000
    s_mov_b32 exec_lo, 0x000f000f
    s_mov_b32 exec_hi, 0x000f000f
    s_cmp_lg_u32 s7, 0
    s_cbranch_scc1 L_slow_15
    buffer_store_dwordx4 v[24:27], v28, s[40:43], s7 offen
L_pub_16:
    buffer_store_byte v31, v40, s[40:43], s73 offen
    s_mov_b64 exec, -1
    s_memtime s[74:75]
    s_lshl_b32 s12, s6, 5
    s_mov_b32 s13, 0x01010101
L_lpt_17:
    s_memtime s[56:57]
    ds_read_b32 v30, v31 offset:3588
    s_waitcnt lgkmcnt(0)
    v_readfirstlane_b32 s10, v30
    s_nop 0
    s_cmp_lg_u32 s10, 0
    s_cbranch_scc1 L_lpz_19
    s_sub_u32 s56, s56, s74
    s_cmp_ge_u32 s56, 1000
    s_cbranch_scc1 L_lpq_18
    s_sleep 1
    s_branch L_lpt_17
L_lpq_18:
    s_buffer_load_dwordx8 s[56:63], s[52:55], s12
    s_waitcnt lgkmcnt(0)
    s_or_b32 s56, s56, 0xff
    s_and_b64 s[56:57], s[56:57], s[58:59]
    s_and_b64 s[60:61], s[60:61], s[62:63]
    s_and_b64 s[56:57], s[56:57], s[60:61]
    s_and_b32 s56, s56, s57
    s_and_b32 s56, s56, s13
    s_cmp_eq_u32 s56, s13
    s_cbranch_scc0 L_lpz_19
    v_mov_b32 v30, 1
    ds_write_b32 v31, v30 offset:3588
L_lpz_19:
L_wf_20:
    ds_read_b32 v30, v31 offset:3588
    s_waitcnt lgkmcnt(0)
    v_readfirstlane_b32 s10, v30
    s_nop 0
    s_cmp_ge_u32 s10, 1
    s_cbranch_scc0 L_wfr_21
    s_cmp_lg_u32 s10, 1
    s_cbranch_scc1 L_l_bq1
    s_cmp_lg_u32 s7, 0
    s_cbranch_scc1 L_hgo_23
    s_mov_b32 s15, 0
L_hint_22:
    s_buffer_load_dwordx8 s[56:63], s[40:43], s72
    s_add_u32 s72, s72, 64
    s_add_u32 s15, s15, 1
    s_waitcnt lgkmcnt(0)
    s_or_b64 s[56:57], s[56:57], s[58:59]
    s_or_b64 s[60:61], s[60:61], s[62:63]
    s_or_b64 s[56:57], s[56:57], s[60:61]
    s_cbranch_scc0 L_hgo_23
    s_cmp_lt_u32 s15, 16
    s_cbranch_scc1 L_hint_22
L_hgo_23:
    s_add_u32 s10, s7, s71
    s_add_u32 s11, s10, 4096
    s_mov_b32 s15, 0
    s_mov_b32 s78, 0
L_qp_24:
    buffer_load_dwordx4 v[192:195], v2, s[40:43], s10 offen offset:0 sc1
    buffer_load_dwordx4 v[196:199], v2, s[40:43], s10 offen offset:1024 sc1
    buffer_load_dwordx4 v[200:203], v2, s[40:43], s10 offen offset:2048 sc1
    buffer_load_dwordx4 v[204:207], v2, s[40:43], s10 offen offset:3072 sc1
    buffer_load_dwordx4 v[208:211], v2, s[40:43], s11 offen offset:0 sc1
    buffer_load_dwordx4 v[212:215], v2, s[40:43], s11 offen offset:1024 sc1
    buffer_load_dwordx4 v[216:219], v2, s[40:43], s11 offen offset:2048 sc1
    buffer_load_dwordx4 v[220:223], v2, s[40:43], s11 offen offset:3072 sc1
    v_mov_b32 v30, 1
    ds_write_b32 v31, v30 offset:3656
    s_add_u32 s78, s78, 1
    s_cmp_lt_u32 s78, s3
    s_waitcnt vmcnt(0)
    v_or3_b32 v8, v192, v196, v200
    v_or3_b32 v8, v8, v204, v208
    v_or3_b32 v8, v8, v212, v216
    v_bitop3_b32 v8, v8, v220, 1 bitop3:0xa8
    v_cmp_ne_u32 vcc, 0, v8
    v_add_f32 v64, v192, v200
    v_add_f32 v72, v208, v216
    v_add_f32 v65, v193, v201
    v_add_f32 v73, v209, v217
    v_add_f32 v66, v194, v202
    v_add_f32_e64 v74, v210, v218
    s_cbranch_vccz L_qok_26
    s_cbranch_scc0 L_qok_26
L_qc_25:
    v_alignbit_b32 v8, v192, 0, 1
    v_alignbit_b32 v8, v196, v8, 1
    v_alignbit_b32 v8, v200, v8, 1
    v_alignbit_b32 v8, v204, v8, 1
    v_alignbit_b32 v8, v208, v8, 1
    v_alignbit_b32 v8, v212, v8, 1
    v_alignbit_b32 v8, v216, v8, 1
    v_alignbit_b32 v8, v220, v8, 1
    v_cmp_ne_u32_e64 vcc, 0, v8
    v_add_f32 v64, v192, v200
    v_add_f32 v72, v208, v216
    v_add_f32 v65, v193, v201
    v_add_f32 v73, v209, v217
    v_add_f32 v66, v194, v202
    v_add_f32 v74, v210, v218
    s_cbranch_vccz L_qok_26
    s_add_u32 s15, s15, 1
    s_cmp_gt_u32 s15, 6
    s_cbranch_scc1 L_qp_24
    s_cmp_lg_u32 s7, 0
    s_cbranch_scc1 L_qp_24
    s_ff1_i32_b64 s12, vcc
    v_readlane_b32 s13, v8, s12
    s_and_b32 s12, s12, 0x38
    s_lshl_b32 s14, s12, 4
    s_add_u32 s14, s14, s10
    s_ff1_i32_b32 s13, s13
    s_sub_u32 s13, s13, 24
    s_lshl_b32 s79, s13, 10
    s_add_u32 s14, s14, s79
    s_buffer_load_dwordx16 s[44:59], s[40:43], s14
    s_add_u32 s14, s14, 64
    s_buffer_load_dwordx16 s[60:75], s[40:43], s14
    s_lshl_b32 s13, s13, 2
    s_mov_b32 m0, s12
    s_waitcnt lgkmcnt(0)
    v_writelane_b32 v224, s44, m0
    v_writelane_b32 v225, s45, m0
    v_writelane_b32 v226, s46, m0
    v_writelane_b32 v227, s47, m0
    s_add_u32 m0, m0, 1
    s_nop 0
    v_writelane_b32 v224, s48, m0
    v_writelane_b32 v225, s49, m0
    v_writelane_b32 v226, s50, m0
    v_writelane_b32 v227, s51, m0
    s_add_u32 m0, m0, 1
    s_nop 0
    v_writelane_b32 v224, s52, m0
    v_writelane_b32 v225, s53, m0
    v_writelane_b32 v226, s54, m0
    v_writelane_b32 v227, s55, m0
    s_add_u32 m0, m0, 1
    s_nop 0
    v_writelane_b32 v224, s56, m0
    v_writelane_b32 v225, s57, m0
    v_writelane_b32 v226, s58, m0
    v_writelane_b32 v227, s59, m0
    s_add_u32 m0, m0, 1
    s_nop 0
    v_writelane_b32 v224, s60, m0
    v_writelane_b32 v225, s61, m0
    v_writelane_b32 v226, s62, m0
    v_writelane_b32 v227, s63, m0
    s_add_u32 m0, m0, 1
    s_nop 0
    v_writelane_b32 v224, s64, m0
    v_writelane_b32 v225, s65, m0
    v_writelane_b32 v226, s66, m0
    v_writelane_b32 v227, s67, m0
    s_add_u32 m0, m0, 1
    s_nop 0
    v_writelane_b32 v224, s68, m0
    v_writelane_b32 v225, s69, m0
    v_writelane_b32 v226, s70, m0
    v_writelane_b32 v227, s71, m0
    s_add_u32 m0, m0, 1
    s_nop 0
    v_writelane_b32 v224, s72, m0
    v_writelane_b32 v225, s73, m0
    v_writelane_b32 v226, s74, m0
    v_writelane_b32 v227, s75, m0
    s_lshl_b64 exec, 0xff, s12
    s_set_gpr_idx_on s13, gpr_idx(DST)
    s_nop 0
    v_mov_b32 v192, v224
    v_mov_b32 v193, v225
    v_mov_b32 v194, v226
    v_mov_b32 v195, v227
    s_set_gpr_idx_off
    s_mov_b64 exec, -1
    s_branch L_qc_25
    s_nop 0
L_qok_26:
    v_add_f32 v67, v195, v203
    v_add_f32 v75, v211, v219
    v_add_f32 v68, v196, v204
    v_add_f32 v76, v212, v220
    v_add_f32 v69, v197, v205
    v_add_f32 v77, v213, v221
    v_add_f32 v70, v198, v206
    v_add_f32 v78, v214, v222
    v_add_f32 v71, v199, v207
    v_add_f32 v79, v215, v223
    v_add_f32 v64, v64, v72
    v_add_f32 v65, v65, v73
    v_add_f32 v66, v66, v74
    v_add_f32 v67, v67, v75
    v_add_f32 v68, v68, v76
    v_add_f32 v69, v69, v77
    v_add_f32 v70, v70, v78
    v_add_f32 v71, v71, v79
    v_cvt_pk_bf16_f32 v4, v64, v65
    v_cvt_pk_bf16_f32 v5, v66, v67
    v_cvt_pk_bf16_f32 v6, v68, v69
    v_cvt_pk_bf16_f32 v7, v70, v71
    ds_write_b128 v33, v[4:7] offset:1024
    s_waitcnt lgkmcnt(0)
L_l_bq1:
    v_mov_b32 v30, 1
    ds_write_b32 v31, v30 offset:3656
    s_barrier
    ds_read_b32 v30, v31 offset:3584
    s_waitcnt lgkmcnt(0)
    v_readfirstlane_b32 s10, v30
    s_nop 0
    s_cmp_eq_u32 s10, 0
    s_cbranch_scc0 L_fallback
    v_mov_b32 v20, 0x3f803f80
    v_mov_b32 v21, 0x3f803f80
    v_mov_b32 v22, 0x3f803f80
    v_mov_b32 v23, 0x3f803f80
    v_mov_b32 v8, 0x10000000
    v_cmp_gt_u32 vcc, 4, v0
    s_nop 1
    v_cndmask_b32 v29, v8, v29, vcc
    s_barrier
    ds_read_b128 v[8:11], v35 offset:3072
    ds_read_b128 v[128:131], v34 offset:2048
    ds_read_b128 v[132:135], v34 offset:2304
    ds_read_b128 v[136:139], v34 offset:2560
    ds_read_b128 v[140:143], v34 offset:2816
    ds_read_b32 v18, v31 offset:3624
    s_waitcnt lgkmcnt(4)
    v_mfma_f32_16x16x32_bf16 v[144:147], v[20:23], v[128:131], 0
    v_max_f32 v16, v8, v9
    v_max3_f32 v16, v16, v10, v11
    s_waitcnt lgkmcnt(3)
    v_mfma_f32_16x16x32_bf16 v[148:151], v[20:23], v[132:135], 0
    v_sub_f32 v8, v8, v16
    v_sub_f32 v9, v9, v16
    s_waitcnt lgkmcnt(2)
    v_mfma_f32_16x16x32_bf16 v[152:155], v[20:23], v[136:139], 0
    v_sub_f32_e64 v10, v10, v16
    v_sub_f32 v11, v11, v16
    s_waitcnt lgkmcnt(1)
    v_mfma_f32_16x16x32_bf16 v[156:159], v[20:23], v[140:143], 0
    v_exp_f32 v8, v8
    v_exp_f32 v9, v9
    v_exp_f32 v10, v10
    v_exp_f32 v11, v11
    s_cmp_lg_u32 s7, 0
    s_waitcnt lgkmcnt(0)
    v_lshlrev_b32 v18, 1, v18
    v_mul_f32 v17, v8, v144
    v_fmac_f32 v17, v9, v148
    v_fmac_f32 v17, v10, v152
    v_fmac_f32 v17, v11, v156
    v_and_or_b32 v17, v17, -16, v18
    s_cbranch_scc1 L_slow_27
    buffer_store_dwordx2 v[16:17], v29, s[40:43], s7 offen
L_pub_28:
L_wf_29:
    ds_read_b32 v30, v31 offset:3604
    s_waitcnt lgkmcnt(0)
    v_readfirstlane_b32 s10, v30
    s_nop 0
    s_cmp_ge_u32 s10, 3
    s_cbranch_scc0 L_wfr_30
    s_cmp_ge_u32 s10, 0x100
    s_cbranch_scc1 L_l_abort
    s_mov_b32 s65, 0
    buffer_load_dwordx4 v[40:43], v2, s[40:43], s77 offen sc1
    s_nop 15
    s_nop 15
    s_nop 15
L_gp_31:
    buffer_load_dwordx4 v[44:47], v2, s[40:43], s77 offen sc1
    s_add_u32 s65, s65, 1
    s_cmp_lt_u32 s65, s3
    s_cbranch_scc0 L_gz_35
    s_waitcnt vmcnt(1)
    v_cmp_eq_u32 vcc, -1, v40
    ds_write_b128 v2, v[40:43] offset:0
    s_cbranch_vccz L_gd_32
    buffer_load_dwordx4 v[40:43], v2, s[40:43], s77 offen sc1
    s_waitcnt vmcnt(1)
    v_cmp_eq_u32 vcc, -1, v44
    ds_write_b128 v2, v[44:47] offset:0
    s_cbranch_vccnz L_gp_31
L_gz_35:
L_gd_32:
    s_waitcnt lgkmcnt(0)
L_l_abort:
    s_barrier
    s_barrier
    ds_read_b32 v30, v31 offset:3584
    s_waitcnt lgkmcnt(0)
    v_readfirstlane_b32 s10, v30
    s_nop 0
    s_cmp_eq_u32 s10, 0
    s_cbranch_scc0 L_fallback
    v_mov_b32 v20, 0x3f803f80
    v_mov_b32 v21, 0x3f803f80
    v_mov_b32 v22, 0x3f803f80
    v_mov_b32 v23, 0x3f803f80
    s_barrier
    ds_read_b128 v[8:11], v35 offset:3072
    ds_read_b128 v[128:131], v34 offset:2048
    ds_read_b128 v[132:135], v34 offset:2304
    ds_read_b128 v[136:139], v34 offset:2560
    ds_read_b128 v[140:143], v34 offset:2816
    s_waitcnt lgkmcnt(3)
    v_mfma_f32_16x16x32_bf16 v[144:147], v[20:23], v[128:131], 0
    v_max_f32 v16, v8, v9
    v_max3_f32 v16, v16, v10, v11
    s_waitcnt lgkmcnt(2)
    v_mfma_f32_16x16x32_bf16 v[148:151], v[20:23], v[132:135], 0
    v_sub_f32 v8, v8, v16
    v_sub_f32 v9, v9, v16
    s_waitcnt lgkmcnt(1)
    v_mfma_f32_16x16x32_bf16 v[152:155], v[20:23], v[136:139], 0
    v_sub_f32_e64 v10, v10, v16
    v_sub_f32 v11, v11, v16
    s_waitcnt lgkmcnt(0)
    v_mfma_f32_16x16x32_bf16 v[156:159], v[20:23], v[140:143], 0
    v_exp_f32 v8, v8
    v_exp_f32 v9, v9
    v_exp_f32 v10, v10
    v_exp_f32 v11, v11
    s_cmp_lg_u32 s7, 0
    v_mul_f32 v17, v8, v144
    v_fmac_f32 v17, v9, v148
    v_fmac_f32 v17, v10, v152
    v_fmac_f32 v17, v11, v156
    v_and_or_b32 v17, v17, -16, 12
    s_cbranch_scc1 L_slow_36
    buffer_store_dwordx2 v[16:17], v29, s[40:43], s7 offen
L_pub_37:
    s_endpgm
    s_nop 0
L_wad_14:
    s_nop 4
    s_sleep 1
    s_branch L_wa_13
L_slow_15:
    s_nop 4
    buffer_store_dwordx4 v[24:27], v28, s[40:43], s7 offen sc1
    s_branch L_pub_16
L_wfr_21:
    s_nop 4
    s_sleep 1
    s_branch L_wf_20
    s_nop 0
L_slow_27:
    s_nop 4
    buffer_store_dwordx2 v[16:17], v29, s[40:43], s7 offen sc1
    s_branch L_pub_28
    s_nop 0
L_wfr_30:
    s_nop 4
    s_sleep 1
    s_branch L_wf_29
L_slow_36:
    s_nop 4
    buffer_store_dwordx2 v[16:17], v29, s[40:43], s7 offen sc1
    s_branch L_pub_37
L_roleO:
    s_setprio 3
    v_lshlrev_b32 v2, 4, v0
    v_mov_b32 v16, -1
    v_mov_b32 v17, -1
    v_mov_b32 v18, -1
    v_mov_b32 v19, -1
    s_lshl_b32 s10, s9, 11
    s_add_u32 s10, s10, 0x100000
    v_add_u32_e64 v7, s10, v2
    s_lshl_b32 s10, s6, 10
    s_add_u32 s10, s10, 0x10000
    v_lshl_add_u32 v8, v0, 7, s10
    s_and_b32 s12, s5, 3
    s_lshl_b32 s12, s12, 11
    s_lshr_b32 s13, s5, 2
    s_lshl_b32 s13, s13, 7
    s_add_u32 s12, s12, s13
    s_lshl_b32 s13, s6, 13
    s_add_u32 s12, s12, s13
    s_add_u32 s12, s12, 0x1e000
    v_lshl_add_u32 v9, v0, 10, s12
    v_cmp_gt_u32 vcc, 8, v0
    s_nop 1
    v_cndmask_b32 v8, v9, v8, vcc
    s_waitcnt lgkmcnt(0)
    s_mov_b32 s40, s38
    s_and_b32 s41, s39, 0xffff
    s_mov_b32 s42, 0x10000000
    s_mov_b32 s43, 0x20000
    s_mov_b32 s44, s24
    s_and_b32 s45, s25, 0xffff
    s_mov_b32 s46, 0x400000
    s_mov_b32 s47, 0x20000
    s_barrier
    s_barrier
    buffer_store_dwordx4 v[16:19], v7, s[40:43], s7 offen sc1
    buffer_store_dwordx4 v[16:19], v7, s[40:43], s7 offen offset:1024 sc1
    s_mov_b64 exec, 0x3ff
    buffer_load_dword v251, v8, s[40:43], 0 offen sc1
    s_mov_b64 exec, -1
    s_barrier
    s_mov_b32 s77, 0x05040100
    s_mov_b32 s78, 0x07060302
    s_lshl_b32 s14, s6, 16
    s_lshl_b32 s13, s5, 6
    s_add_u32 s14, s14, 0x100000
    v_lshrrev_b32_e64 v4, 2, v0
    v_lshl_add_u32 v5, v4, 7, s13
    v_and_b32 v5, 0x7ff, v5
    v_lshl_add_u32 v4, v4, 11, v5
    v_and_b32 v3, 3, v0
    v_lshl_add_u32 v4, v3, 4, v4
    v_add_u32 v4, s14, v4
    v_add_u32 v5, 0x8000, v4
    s_lshl_b32 s10, s6, 11
    s_lshr_b32 s11, s5, 3
    s_lshl_b32 s11, s11, 8
    s_add_u32 s10, s10, s11
    s_add_u32 s10, s10, 0x8000
    v_lshrrev_b32_e64 v1, 2, v0
    v_lshl_add_u32 v3, v1, 4, s10
    s_lshl_b32 s10, s9, 11
    s_add_u32 s10, s10, 0x180000
    s_lshl_b32 s11, s5, 7
    v_lshl_add_u32 v6, v0, 5, s11
    v_and_b32 v6, 0x7ff, v6
    v_add_u32_e64 v6, s10, v6
    s_waitcnt vmcnt(1)
    v_mov_b32 v30, 1
    ds_write_b32 v31, v30 offset:3628
    s_getpc_b64 s[66:67]
L_pc_38:
    s_lshl_b32 s68, s5, 10
    s_add_u32 s68, s68, 0
    s_min_u32 s68, s68, L_code_end-interleave_layers__sliding_block_cached__glu_gated_glu__decode_kernel-388
    s_sub_u32 s66, s66, L_pc_38-interleave_layers__sliding_block_cached__glu_gated_glu__decode_kernel
    s_subb_u32 s67, s67, 0
    s_add_u32 s66, s66, s68
    s_addc_u32 s67, s67, 0
    s_load_dword s70, s[66:67], 0
    s_load_dword s71, s[66:67], 128
    s_load_dword s72, s[66:67], 256
    s_load_dword s73, s[66:67], 384
L_wa_39:
    ds_read_b128 v[8:11], v31 offset:3632
    s_waitcnt lgkmcnt(0)
    v_min_u32 v8, v8, v9
    v_min3_u32 v8, v8, v10, v11
    s_nop 0
    v_readfirstlane_b32 s10, v8
    s_nop 0
    s_cmp_lg_u32 s10, 0
    s_cbranch_scc0 L_wad_40
L_wf_41:
    ds_read_b32 v30, v31 offset:3656
    s_waitcnt lgkmcnt(0)
    v_readfirstlane_b32 s10, v30
    s_nop 0
    s_cmp_ge_u32 s10, 1
    s_cbranch_scc0 L_wfr_42
    s_lshl_b32 s10, s9, 14
    s_nop 0
    buffer_load_dwordx4 v[64:67], v2, s[44:47], s10 offen offset:0 nt
    buffer_load_dwordx4 v[68:71], v2, s[44:47], s10 offen offset:1024 nt
    buffer_load_dwordx4 v[72:75], v2, s[44:47], s10 offen offset:2048 nt
    buffer_load_dwordx4 v[76:79], v2, s[44:47], s10 offen offset:3072 nt
    s_add_u32 s10, s10, 4096
    buffer_load_dwordx4 v[80:83], v2, s[44:47], s10 offen offset:0 nt
    buffer_load_dwordx4 v[84:87], v2, s[44:47], s10 offen offset:1024 nt
    buffer_load_dwordx4 v[88:91], v2, s[44:47], s10 offen offset:2048 nt
    buffer_load_dwordx4 v[92:95], v2, s[44:47], s10 offen offset:3072 nt
    s_add_u32 s10, s10, 4096
    buffer_load_dwordx4 v[96:99], v2, s[44:47], s10 offen offset:0 nt
    buffer_load_dwordx4 v[100:103], v2, s[44:47], s10 offen offset:1024 nt
    buffer_load_dwordx4 v[104:107], v2, s[44:47], s10 offen offset:2048 nt
    buffer_load_dwordx4 v[108:111], v2, s[44:47], s10 offen offset:3072 nt
    s_add_u32 s10, s10, 4096
    buffer_load_dwordx4 v[112:115], v2, s[44:47], s10 offen offset:0 nt
    buffer_load_dwordx4 v[116:119], v2, s[44:47], s10 offen offset:1024 nt
    buffer_load_dwordx4 v[120:123], v2, s[44:47], s10 offen offset:2048 nt
    buffer_load_dwordx4 v[124:127], v2, s[44:47], s10 offen offset:3072 nt
    s_barrier
    ds_read_b32 v30, v31 offset:3584
    s_waitcnt lgkmcnt(0)
    v_readfirstlane_b32 s10, v30
    s_nop 0
    s_cmp_eq_u32 s10, 0
    s_cbranch_scc0 L_fallback
    s_barrier
    s_waitcnt vmcnt(0)
    v_perm_b32 v128, v68, v64, s77
    v_perm_b32 v129, v68, v64, s78
    v_perm_b32 v130, v69, v65, s77
    v_perm_b32 v131, v69, v65, s78
    v_perm_b32 v132, v70, v66, s77
    v_perm_b32 v133, v70, v66, s78
    v_perm_b32 v134, v71, v67, s77
    v_perm_b32 v135, v71, v67, s78
    v_perm_b32 v136, v76, v72, s77
    v_perm_b32 v137, v76, v72, s78
    v_perm_b32 v138, v77, v73, s77
    v_perm_b32 v139, v77, v73, s78
    v_perm_b32 v140, v78, v74, s77
    v_perm_b32 v141, v78, v74, s78
    v_perm_b32 v142, v79, v75, s77
    v_perm_b32 v143, v79, v75, s78
    v_perm_b32 v144, v84, v80, s77
    v_perm_b32 v145, v84, v80, s78
    v_perm_b32 v146, v85, v81, s77
    v_perm_b32 v147, v85, v81, s78
    v_perm_b32 v148, v86, v82, s77
    v_perm_b32 v149, v86, v82, s78
    v_perm_b32 v150, v87, v83, s77
    v_perm_b32 v151, v87, v83, s78
    v_perm_b32 v152, v92, v88, s77
    v_perm_b32 v153, v92, v88, s78
    v_perm_b32 v154, v93, v89, s77
    v_perm_b32 v155, v93, v89, s78
    v_perm_b32 v156, v94, v90, s77
    v_perm_b32 v157, v94, v90, s78
    v_perm_b32 v158, v95, v91, s77
    v_perm_b32 v159, v95, v91, s78
    v_perm_b32 v160, v100, v96, s77
    v_perm_b32 v161, v100, v96, s78
    v_perm_b32 v162, v101, v97, s77
    v_perm_b32 v163, v101, v97, s78
    v_perm_b32 v164, v102, v98, s77
    v_perm_b32 v165, v102, v98, s78
    v_perm_b32 v166, v103, v99, s77
    v_perm_b32 v167, v103, v99, s78
    v_perm_b32 v168, v108, v104, s77
    v_perm_b32 v169, v108, v104, s78
    v_perm_b32 v170, v109, v105, s77
    v_perm_b32 v171, v109, v105, s78
    v_perm_b32 v172, v110, v106, s77
    v_perm_b32 v173, v110, v106, s78
    v_perm_b32 v174, v111, v107, s77
    v_perm_b32 v175, v111, v107, s78
    v_perm_b32 v176, v116, v112, s77
    v_perm_b32 v177, v116, v112, s78
    v_perm_b32 v178, v117, v113, s77
    v_perm_b32 v179, v117, v113, s78
    v_perm_b32 v180, v118, v114, s77
    v_perm_b32 v181, v118, v114, s78
    v_perm_b32 v182, v119, v115, s77
    v_perm_b32 v183, v119, v115, s78
    v_perm_b32 v184, v124, v120, s77
    v_perm_b32 v185, v124, v120, s78
    v_perm_b32 v186, v125, v121, s77
    v_perm_b32 v187, v125, v121, s78
    v_perm_b32 v188, v126, v122, s77
    v_perm_b32 v189, v126, v122, s78
    v_perm_b32 v190, v127, v123, s77
    v_perm_b32 v191, v127, v123, s78
    v_mov_b32 v32, -1
    v_mov_b32 v33, -1
    v_mov_b32 v34, -1
    v_mov_b32 v35, -1
    v_mov_b32 v36, -1
    v_mov_b32 v37, -1
    v_mov_b32 v38, -1
    v_mov_b32 v39, -1
    v_mov_b32 v40, -1
    v_mov_b32 v41, -1
    v_mov_b32_e64 v42, -1
    v_mov_b32 v43, -1
    s_mov_b32 s65, 0
    s_nop 15
    s_nop 15
    s_nop 15
    s_nop 15
    s_nop 15
    s_nop 15
L_kp_43:
    buffer_load_dwordx4 v[32:35], v4, s[40:43], s7 offen sc1
    buffer_load_dwordx4 v[36:39], v5, s[40:43], s7 offen sc1
    buffer_load_dwordx4 v[40:43], v3, s[40:43], s7 offen sc1
    v_max_u32_e64 v22, v32, v33
    v_max3_u32 v22, v22, v34, v35
    v_max3_u32 v22, v22, v36, v37
    v_max3_u32 v22, v22, v38, v39
    v_max3_u32 v22, v22, v40, v41
    v_max3_u32 v22, v22, v42, v43
    v_cmp_eq_u32 vcc, -1, v22
    v_max_f32 v18, v40, v42
    v_bfe_u32 v20, v41, 2, 2
    v_bfe_u32 v21, v43, 2, 2
    v_max_f32_dpp v18, v18, v18 row_ror:4 row_mask:0xf bank_mask:0xf
    s_nop 1
    v_max_f32_dpp v18, v18, v18 row_ror:8 row_mask:0xf bank_mask:0xf
    s_cbranch_vccz L_kd_44
    v_max_u32_e64 v22, v32, v33
    v_max3_u32 v22, v22, v34, v35
    v_max3_u32 v22, v22, v36, v37
    v_max3_u32 v22, v22, v38, v39
    v_max3_u32 v22, v22, v40, v41
    v_max3_u32 v22, v22, v42, v43
    v_cmp_eq_u32 vcc, -1, v22
    v_max_f32 v18, v40, v42
    v_bfe_u32 v20, v41, 2, 2
    v_bfe_u32 v21, v43, 2, 2
    v_max_f32_dpp v18, v18, v18 row_ror:4 row_mask:0xf bank_mask:0xf
    s_nop 1
    v_max_f32_dpp v18, v18, v18 row_ror:8 row_mask:0xf bank_mask:0xf
    s_cbranch_vccz L_kd_44
    v_max_u32_e64 v22, v32, v33
    v_max3_u32 v22, v22, v34, v35
    v_max3_u32 v22, v22, v36, v37
    v_max3_u32 v22, v22, v38, v39
    v_max3_u32 v22, v22, v40, v41
    v_max3_u32 v22, v22, v42, v43
    v_cmp_eq_u32 vcc, -1, v22
    v_max_f32 v18, v40, v42
    v_bfe_u32 v20, v41, 2, 2
    v_bfe_u32 v21, v43, 2, 2
    v_max_f32_dpp v18, v18, v18 row_ror:4 row_mask:0xf bank_mask:0xf
    s_nop 1
    v_max_f32_dpp v18, v18, v18 row_ror:8 row_mask:0xf bank_mask:0xf
    s_cbranch_vccz L_kd_44
    v_max_u32_e64 v22, v32, v33
    v_max3_u32 v22, v22, v34, v35
    v_max3_u32 v22, v22, v36, v37
    v_max3_u32 v22, v22, v38, v39
    v_max3_u32 v22, v22, v40, v41
    v_max3_u32 v22, v22, v42, v43
    v_cmp_eq_u32 vcc, -1, v22
    v_max_f32 v18, v40, v42
    v_bfe_u32 v20, v41, 2, 2
    v_bfe_u32 v21, v43, 2, 2
    v_max_f32_dpp v18, v18, v18 row_ror:4 row_mask:0xf bank_mask:0xf
    s_nop 1
    v_max_f32_dpp v18, v18, v18 row_ror:8 row_mask:0xf bank_mask:0xf
    s_cbranch_vccz L_kd_44
    s_add_u32 s65, s65, 1
    s_cmp_lt_u32 s65, s3
    s_cbranch_scc1 L_kp_43
L_kd_44:
    v_mov_b32 v19, v18
    v_mov_b32_e64 v30, 1
    ds_write_b32 v31, v30 offset:3600
    v_permlane16_swap_b32 v18, v19
    v_max_f32 v18, v18, v19
    v_mov_b32 v19, v18
    s_nop 1
    v_permlane32_swap_b32 v18, v19
    v_max_f32 v18, v18, v19
    v_sub_f32 v16, v40, v18
    v_sub_f32 v19, v42, v18
    v_exp_f32 v16, v16
    v_exp_f32 v19, v19
    v_pk_mul_f32 v[8:9], v[16:17], v[32:33] op_sel_hi:[0,1]
    v_pk_mul_f32 v[10:11], v[16:17], v[34:35] op_sel_hi:[0,1]
    v_mul_f32_e64 v17, v16, v41
    v_pk_fma_f32 v[8:9], v[18:19], v[36:37], v[8:9] op_sel:[1,0,0] op_sel_hi:[1,1,1]
    v_pk_fma_f32 v[10:11], v[18:19], v[38:39], v[10:11] op_sel:[1,0,0] op_sel_hi:[1,1,1]
    v_fmac_f32_e64 v17, v19, v43
    v_permlane32_swap_b32 v8, v9
    v_permlane32_swap_b32 v10, v11
    v_add_f32_dpp v17, v17, v17 row_ror:4 row_mask:0xf bank_mask:0xf
    v_add_f32 v8, v8, v9
    v_add_f32 v10, v10, v11
    v_add_f32_dpp v17, v17, v17 row_ror:8 row_mask:0xf bank_mask:0xf
    v_mov_b32 v19, v17
    v_permlane16_swap_b32 v8, v10
    v_add_f32 v8, v8, v10
    v_permlane16_swap_b32 v17, v19
    v_add_f32_e64 v17, v17, v19
    v_add_f32_dpp v8, v8, v8 row_ror:4 row_mask:0xf bank_mask:0xf
    v_mov_b32 v19, v17
    s_cmp_lg_u32 s7, 0
    v_add_f32_dpp v8, v8, v8 row_ror:8 row_mask:0xf bank_mask:0xf
    v_permlane32_swap_b32 v17, v19
    v_mov_b32 v9, v8
    v_add_f32 v17, v17, v19
    v_rcp_f32 v17, v17
    v_permlane32_swap_b32 v8, v9
    v_pk_mul_f32 v[8:9], v[16:17], v[8:9] op_sel:[1,0] op_sel_hi:[1,1]
    v_cvt_pk_bf16_f32 v8, v8, v9
    s_nop 0
    v_readlane_b32 s66, v8, 0
    v_readlane_b32 s67, v8, 16
    v_readlane_b32 s68, v8, 1
    v_readlane_b32 s69, v8, 17
    v_readlane_b32 s70, v8, 2
    v_readlane_b32 s71, v8, 18
    v_readlane_b32 s72, v8, 3
    v_readlane_b32 s73, v8, 19
    v_dot2_f32_bf16 v8, v128, s66, 0
    v_dot2_f32_bf16 v9, v129, s66, 0
    v_dot2_f32_bf16 v10, v130, s66, 0
    v_dot2_f32_bf16 v11, v131, s66, 0
    v_dot2_f32_bf16 v12, v132, s66, 0
    v_dot2_f32_bf16 v13, v133, s66, 0
    v_dot2_f32_bf16 v14, v134, s66, 0
    v_dot2_f32_bf16 v15, v135, s66, 0
    v_dot2c_f32_bf16 v8, s67, v136
    v_dot2c_f32_bf16 v9, s67, v137
    v_dot2c_f32_bf16 v10, s67, v138
    v_dot2c_f32_bf16 v11, s67, v139
    v_dot2c_f32_bf16 v12, s67, v140
    v_dot2c_f32_bf16 v13, s67, v141
    v_dot2c_f32_bf16 v14, s67, v142
    v_dot2c_f32_bf16 v15, s67, v143
    v_dot2c_f32_bf16 v8, s68, v144
    v_dot2c_f32_bf16 v9, s68, v145
    v_dot2c_f32_bf16 v10, s68, v146
    v_dot2c_f32_bf16 v11, s68, v147
    v_dot2c_f32_bf16 v12, s68, v148
    v_dot2c_f32_bf16 v13, s68, v149
    v_dot2c_f32_bf16 v14, s68, v150
    v_dot2c_f32_bf16 v15, s68, v151
    v_dot2c_f32_bf16 v8, s69, v152
    v_dot2c_f32_bf16 v9, s69, v153
    v_dot2c_f32_bf16 v10, s69, v154
    v_dot2c_f32_bf16 v11, s69, v155
    v_dot2c_f32_bf16 v12, s69, v156
    v_dot2c_f32_bf16 v13, s69, v157
    v_dot2c_f32_bf16 v14, s69, v158
    v_dot2c_f32_bf16 v15, s69, v159
    v_dot2c_f32_bf16 v8, s70, v160
    v_dot2c_f32_bf16 v9, s70, v161
    v_dot2c_f32_bf16 v10, s70, v162
    v_dot2c_f32_bf16 v11, s70, v163
    v_dot2c_f32_bf16 v12, s70, v164
    v_dot2c_f32_bf16 v13, s70, v165
    v_dot2c_f32_bf16 v14, s70, v166
    v_dot2c_f32_bf16 v15, s70, v167
    v_dot2c_f32_bf16 v8, s71, v168
    v_dot2c_f32_bf16 v9, s71, v169
    v_dot2c_f32_bf16 v10, s71, v170
    v_dot2c_f32_bf16 v11, s71, v171
    v_dot2c_f32_bf16 v12, s71, v172
    v_dot2c_f32_bf16 v13, s71, v173
    v_dot2c_f32_bf16 v14, s71, v174
    v_dot2c_f32_bf16 v15, s71, v175
    v_dot2c_f32_bf16 v8, s72, v176
    v_dot2c_f32_bf16 v9, s72, v177
    v_dot2c_f32_bf16 v10, s72, v178
    v_dot2c_f32_bf16 v11, s72, v179
    v_dot2c_f32_bf16 v12, s72, v180
    v_dot2c_f32_bf16 v13, s72, v181
    v_dot2c_f32_bf16 v14, s72, v182
    v_dot2c_f32_bf16 v15, s72, v183
    v_dot2c_f32_bf16 v8, s73, v184
    v_dot2c_f32_bf16 v9, s73, v185
    v_dot2c_f32_bf16 v10, s73, v186
    v_dot2c_f32_bf16 v11, s73, v187
    v_dot2c_f32_bf16 v12, s73, v188
    v_dot2c_f32_bf16 v13, s73, v189
    v_dot2c_f32_bf16 v14, s73, v190
    v_dot2c_f32_bf16 v15, s73, v191
    v_and_or_b32 v8, v8, -16, 14
    v_and_or_b32 v12, v12, -16, 14
    s_cbranch_scc1 L_slow_45
    buffer_store_dwordx4 v[8:11], v6, s[40:43], s7 offen
    buffer_store_dwordx4 v[12:15], v6, s[40:43], s7 offen offset:16
L_pub_46:
    v_cmp_eq_u32 vcc, 1, v20
    s_nop 0
    s_bcnt1_i32_b64 s10, vcc
    v_cmp_eq_u32 vcc, 1, v21
    s_nop 0
    s_bcnt1_i32_b64 s12, vcc
    v_cmp_eq_u32 vcc, 2, v20
    s_nop 0
    s_bcnt1_i32_b64 s11, vcc
    v_cmp_eq_u32 vcc, 2, v21
    s_nop 0
    s_bcnt1_i32_b64 s13, vcc
    s_add_u32 s10, s10, s12
    s_add_u32 s11, s11, s13
    s_cmp_gt_u32 s11, s10
    s_cselect_b32 s10, 1, 0
    s_lshr_b32 s11, s4, 2
    s_xor_b32 s10, s10, s11
    s_add_u32 s10, s10, 1
    v_mov_b32 v30, s10
    ds_write_b32 v31, v30 offset:3648
    s_waitcnt vmcnt(0)
    s_barrier
    s_barrier
    ds_read_b32 v30, v31 offset:3584
    s_waitcnt lgkmcnt(0)
    v_readfirstlane_b32 s10, v30
    s_nop 0
    s_cmp_eq_u32 s10, 0
    s_cbranch_scc0 L_fallback
    s_barrier
    s_mov_b32 s65, 0
    s_nop 15
    s_nop 15
    s_nop 15
    s_nop 15
    s_nop 15
    s_nop 15
    s_nop 15
    s_nop 15
    s_nop 15
    s_nop 15
    s_nop 15
    buffer_load_dwordx4 v[32:35], v4, s[40:43], s7 offen sc1
    buffer_load_dwordx4 v[36:39], v5, s[40:43], s7 offen sc1
    buffer_load_dwordx4 v[40:43], v3, s[40:43], s7 offen sc1
    s_nop 15
    s_nop 15
L_gp_47:
    buffer_load_dwordx4 v[44:47], v4, s[40:43], s7 offen sc1
    buffer_load_dwordx4 v[48:51], v5, s[40:43], s7 offen sc1
    buffer_load_dwordx4 v[52:55], v3, s[40:43], s7 offen sc1
    s_add_u32 s65, s65, 1
    s_cmp_lt_u32 s65, s3
    s_cbranch_scc0 L_gz_51
    s_waitcnt vmcnt(3)
    v_or_b32_e64 v23, v41, v43
    v_lshl_or_b32 v23, v23, 1, v36
    v_bitop3_b32 v22, v32, v23, 4 bitop3:0xa8
    v_cmp_ne_u32 vcc, 0, v22
    v_max_f32 v18, v40, v42
    s_nop 1
    v_max_f32_dpp v18, v18, v18 row_ror:4 row_mask:0xf bank_mask:0xf
    s_nop 1
    v_max_f32_dpp v18, v18, v18 row_ror:8 row_mask:0xf bank_mask:0xf
    s_cbranch_vccnz L_gx_52
    v_mov_b32 v19, v18
    v_mov_b32_e64 v30, 2
    ds_write_b32 v31, v30 offset:3600
    v_permlane16_swap_b32 v18, v19
    v_max_f32 v18, v18, v19
    v_mov_b32 v19, v18
    s_nop 1
    v_permlane32_swap_b32 v18, v19
    v_max_f32 v18, v18, v19
    v_sub_f32 v16, v40, v18
    v_sub_f32 v19, v42, v18
    v_exp_f32 v16, v16
    v_exp_f32 v19, v19
    v_pk_mul_f32 v[8:9], v[16:17], v[32:33] op_sel_hi:[0,1]
    v_pk_mul_f32 v[10:11], v[16:17], v[34:35] op_sel_hi:[0,1]
    v_mul_f32_e64 v17, v16, v41
    v_pk_fma_f32 v[8:9], v[18:19], v[36:37], v[8:9] op_sel:[1,0,0] op_sel_hi:[1,1,1]
    v_pk_fma_f32 v[10:11], v[18:19], v[38:39], v[10:11] op_sel:[1,0,0] op_sel_hi:[1,1,1]
    v_fmac_f32 v17, v19, v43
    s_branch L_gd_48
L_gx_52:
    buffer_load_dwordx4 v[32:35], v4, s[40:43], s7 offen sc1
    buffer_load_dwordx4 v[36:39], v5, s[40:43], s7 offen sc1
    buffer_load_dwordx4 v[40:43], v3, s[40:43], s7 offen sc1
    s_waitcnt vmcnt(3)
    v_or_b32 v23, v53, v55
    v_lshl_or_b32 v23, v23, 1, v48
    v_bitop3_b32 v22, v44, v23, 4 bitop3:0xa8
    v_cmp_ne_u32 vcc, 0, v22
    v_max_f32 v18, v52, v54
    s_nop 1
    v_max_f32_dpp v18, v18, v18 row_ror:4 row_mask:0xf bank_mask:0xf
    s_nop 1
    v_max_f32_dpp v18, v18, v18 row_ror:8 row_mask:0xf bank_mask:0xf
    s_cbranch_vccnz L_gp_47
L_gz_51:
    v_mov_b32 v19, v18
    v_mov_b32_e64 v30, 2
    ds_write_b32 v31, v30 offset:3600
    v_permlane16_swap_b32 v18, v19
    v_max_f32 v18, v18, v19
    v_mov_b32 v19, v18
    s_nop 1
    v_permlane32_swap_b32 v18, v19
    v_max_f32 v18, v18, v19
    v_sub_f32 v16, v52, v18
    v_sub_f32 v19, v54, v18
    v_exp_f32 v16, v16
    v_exp_f32 v19, v19
    v_pk_mul_f32 v[8:9], v[16:17], v[44:45] op_sel_hi:[0,1]
    v_pk_mul_f32 v[10:11], v[16:17], v[46:47] op_sel_hi:[0,1]
    v_mul_f32_e64 v17, v16, v53
    v_pk_fma_f32 v[8:9], v[18:19], v[48:49], v[8:9] op_sel:[1,0,0] op_sel_hi:[1,1,1]
    v_pk_fma_f32 v[10:11], v[18:19], v[50:51], v[10:11] op_sel:[1,0,0] op_sel_hi:[1,1,1]
    v_fmac_f32_e64 v17, v19, v55
L_gd_48:
    v_permlane32_swap_b32 v8, v9
    v_permlane32_swap_b32 v10, v11
    v_add_f32_dpp v17, v17, v17 row_ror:4 row_mask:0xf bank_mask:0xf
    v_add_f32 v8, v8, v9
    v_add_f32 v10, v10, v11
    v_add_f32_dpp v17, v17, v17 row_ror:8 row_mask:0xf bank_mask:0xf
    v_mov_b32_e64 v19, v17
    v_permlane16_swap_b32 v8, v10
    v_add_f32 v8, v8, v10
    v_permlane16_swap_b32 v17, v19
    v_add_f32 v17, v17, v19
    v_add_f32_dpp v8, v8, v8 row_ror:4 row_mask:0xf bank_mask:0xf
    v_mov_b32 v19, v17
    s_cmp_lg_u32 s7, 0
    v_add_f32_dpp v8, v8, v8 row_ror:8 row_mask:0xf bank_mask:0xf
    v_permlane32_swap_b32 v17, v19
    v_mov_b32 v9, v8
    v_add_f32 v17, v17, v19
    v_rcp_f32 v17, v17
    v_permlane32_swap_b32 v8, v9
    v_pk_mul_f32 v[8:9], v[16:17], v[8:9] op_sel:[1,0] op_sel_hi:[1,1]
    v_cvt_pk_bf16_f32 v8, v8, v9
    s_nop 0
    v_readlane_b32 s66, v8, 0
    v_readlane_b32 s67, v8, 16
    v_readlane_b32 s68, v8, 1
    v_readlane_b32 s69, v8, 17
    v_readlane_b32 s70, v8, 2
    v_readlane_b32 s71, v8, 18
    v_readlane_b32 s72, v8, 3
    v_readlane_b32 s73, v8, 19
    v_dot2_f32_bf16 v8, v128, s66, 0
    v_dot2_f32_bf16 v9, v129, s66, 0
    v_dot2_f32_bf16 v10, v130, s66, 0
    v_dot2_f32_bf16 v11, v131, s66, 0
    v_dot2_f32_bf16 v12, v132, s66, 0
    v_dot2_f32_bf16 v13, v133, s66, 0
    v_dot2_f32_bf16 v14, v134, s66, 0
    v_dot2_f32_bf16 v15, v135, s66, 0
    v_dot2c_f32_bf16 v8, s67, v136
    v_dot2c_f32_bf16 v9, s67, v137
    v_dot2c_f32_bf16 v10, s67, v138
    v_dot2c_f32_bf16 v11, s67, v139
    v_dot2c_f32_bf16 v12, s67, v140
    v_dot2c_f32_bf16 v13, s67, v141
    v_dot2c_f32_bf16 v14, s67, v142
    v_dot2c_f32_bf16 v15, s67, v143
    v_dot2c_f32_bf16 v8, s68, v144
    v_dot2c_f32_bf16 v9, s68, v145
    v_dot2c_f32_bf16 v10, s68, v146
    v_dot2c_f32_bf16 v11, s68, v147
    v_dot2c_f32_bf16 v12, s68, v148
    v_dot2c_f32_bf16 v13, s68, v149
    v_dot2c_f32_bf16 v14, s68, v150
    v_dot2c_f32_bf16 v15, s68, v151
    v_dot2c_f32_bf16 v8, s69, v152
    v_dot2c_f32_bf16 v9, s69, v153
    v_dot2c_f32_bf16 v10, s69, v154
    v_dot2c_f32_bf16 v11, s69, v155
    v_dot2c_f32_bf16 v12, s69, v156
    v_dot2c_f32_bf16 v13, s69, v157
    v_dot2c_f32_bf16 v14, s69, v158
    v_dot2c_f32_bf16 v15, s69, v159
    v_dot2c_f32_bf16 v8, s70, v160
    v_dot2c_f32_bf16 v9, s70, v161
    v_dot2c_f32_bf16 v10, s70, v162
    v_dot2c_f32_bf16 v11, s70, v163
    v_dot2c_f32_bf16 v12, s70, v164
    v_dot2c_f32_bf16 v13, s70, v165
    v_dot2c_f32_bf16 v14, s70, v166
    v_dot2c_f32_bf16 v15, s70, v167
    v_dot2c_f32_bf16 v8, s71, v168
    v_dot2c_f32_bf16 v9, s71, v169
    v_dot2c_f32_bf16 v10, s71, v170
    v_dot2c_f32_bf16 v11, s71, v171
    v_dot2c_f32_bf16 v12, s71, v172
    v_dot2c_f32_bf16 v13, s71, v173
    v_dot2c_f32_bf16 v14, s71, v174
    v_dot2c_f32_bf16 v15, s71, v175
    v_dot2c_f32_bf16 v8, s72, v176
    v_dot2c_f32_bf16 v9, s72, v177
    v_dot2c_f32_bf16 v10, s72, v178
    v_dot2c_f32_bf16 v11, s72, v179
    v_dot2c_f32_bf16 v12, s72, v180
    v_dot2c_f32_bf16 v13, s72, v181
    v_dot2c_f32_bf16 v14, s72, v182
    v_dot2c_f32_bf16 v15, s72, v183
    v_dot2c_f32_bf16 v8, s73, v184
    v_dot2c_f32_bf16 v9, s73, v185
    v_dot2c_f32_bf16 v10, s73, v186
    v_dot2c_f32_bf16 v11, s73, v187
    v_dot2c_f32_bf16 v12, s73, v188
    v_dot2c_f32_bf16 v13, s73, v189
    v_dot2c_f32_bf16 v14, s73, v190
    v_dot2c_f32_bf16 v15, s73, v191
    v_and_or_b32 v8, v8, -16, 8
    v_and_or_b32 v12, v12, -16, 8
    s_cbranch_scc1 L_slow_53
    buffer_store_dwordx4 v[8:11], v6, s[40:43], s7 offen
    buffer_store_dwordx4 v[12:15], v6, s[40:43], s7 offen offset:16
L_pub_54:
    s_endpgm
L_wad_40:
    s_nop 4
    s_sleep 1
    s_branch L_wa_39
L_wfr_42:
    s_nop 4
    s_sleep 1
    s_branch L_wf_41
    s_nop 0
L_slow_45:
    s_nop 4
    buffer_store_dwordx4 v[8:11], v6, s[40:43], s7 offen sc1
    buffer_store_dwordx4 v[12:15], v6, s[40:43], s7 offen offset:16 sc1
    s_branch L_pub_46
L_slow_53:
    s_nop 4
    buffer_store_dwordx4 v[8:11], v6, s[40:43], s7 offen sc1
    buffer_store_dwordx4 v[12:15], v6, s[40:43], s7 offen offset:16 sc1
    s_branch L_pub_54
    s_nop 0
L_roleR:
    s_setprio 3
    s_and_b32 s12, s5, 7
    s_lshl_b32 s12, s12, 10
    s_lshr_b32 s13, s5, 3
    s_lshl_b32 s13, s13, 14
    s_add_u32 s12, s12, s13
    s_lshl_b32 s13, s6, 7
    s_add_u32 s12, s12, s13
    s_add_u32 s12, s12, 0x40000
    v_and_b32_e64 v4, 3, v0
    v_lshl_add_u32 v4, v4, 4, s12
    v_bfe_u32 v5, v0, 2, 1
    v_lshl_add_u32 v4, v5, 13, v4
    v_bfe_u32 v5, v0, 3, 1
    v_lshl_add_u32 v4, v5, 16, v4
    v_mov_b32 v16, -1
    v_mov_b32 v17, -1
    v_mov_b32 v18, -1
    v_mov_b32 v19, -1
    s_and_b32 s14, s5, 1
    s_lshl_b32 s15, s14, 2
    s_lshl_b32 exec_lo, 0xf, s15
    s_mov_b32 exec_hi, 0
    s_waitcnt lgkmcnt(0)
    s_mov_b32 s40, s38
    s_and_b32 s41, s39, 0xffff
    s_mov_b32 s42, 0x10000000
    s_mov_b32 s43, 0x20000
    s_barrier
    buffer_store_dwordx4 v[16:19], v4, s[40:43], s7 offen sc1
    s_xor_b32 exec_lo, exec_lo, 0xff
    buffer_store_dwordx4 v[16:19], v4, s[40:43], s7 offen sc1
    s_barrier
    s_mov_b32 exec_lo, 0xff00
    buffer_store_dwordx4 v[16:19], v4, s[40:43], s7 offen sc1
    s_mov_b64 exec, -1
    s_lshl_b32 s10, s9, 11
    s_add_u32 s10, s10, 0x180000
    v_lshl_add_u32 v29, v0, 4, s10
    s_add_u32 s11, s7, 0x80000
    s_cmp_lg_u32 s7, 0
    s_cbranch_scc1 L_slow_55
    buffer_store_dwordx4 v[16:19], v29, s[40:43], s7 offen
    buffer_store_dwordx4 v[16:19], v29, s[40:43], s7 offen offset:1024
L_pub_56:
    s_cmp_lg_u32 s7, 0
    s_cbranch_scc1 L_slow_57
    buffer_store_dwordx4 v[16:19], v29, s[40:43], s11 offen
    buffer_store_dwordx4 v[16:19], v29, s[40:43], s11 offen offset:1024
L_pub_58:
    s_barrier
    s_waitcnt vmcnt(6)
    s_memtime s[66:67]
    s_waitcnt vmcnt(5)
    s_memtime s[68:69]
    s_lshr_b32 s15, s4, 2
    s_xor_b32 s14, s14, s15
    s_lshl_b32 s14, 2, s14
    s_waitcnt lgkmcnt(0)
    s_sub_u32 s66, s68, s66
    s_cmp_gt_u32 s66, 16
    s_cselect_b32 s14, s14, 0
    s_or_b32 s14, s14, 1
    v_mov_b32_e64 v30, s14
    s_waitcnt vmcnt(4)
    ds_write_b32 v31, v30 offset:3624
    s_mov_b32 s48, s16
    s_and_b32 s49, s17, 0xffff
    s_mov_b32 s50, 0x400
    s_mov_b32 s51, 0x20000
    s_mov_b32 s60, s34
    s_and_b32 s61, s35, 0xffff
    s_mov_b32 s62, 0x400
    s_mov_b32 s63, 0x20000
    s_mov_b32 s44, s28
    s_and_b32 s45, s29, 0xffff
    s_mov_b32 s46, 0x1c0000
    s_mov_b32 s47, 0x20000
    s_mov_b32 s52, s30
    s_and_b32 s53, s31, 0xffff
    s_mov_b32 s54, 0x1c0000
    s_mov_b32 s55, 0x20000
    v_and_b32 v1, 31, v0
    v_lshlrev_b32 v2, 4, v1
    s_mul_i32 s12, s5, 57344
    s_mul_i32 s13, s6, 448
    s_add_u32 s12, s12, s13
    v_and_b32 v15, 7, v0
    v_lshrrev_b32 v14, 5, v0
    v_mul_u32_u24 v13, 3584, v14
    v_add_u32 v13, v13, v2
    v_mov_b32 v64, 0x3f803f80
    v_mov_b32 v65, 0x3f803f80
    v_mov_b32 v66, 0x3f803f80
    v_mov_b32 v67, 0x3f803f80
    v_mov_b32 v68, 0x3f803f80
    v_mov_b32 v69, 0x3f803f80
    v_mov_b32 v70, 0x3f803f80
    v_mov_b32 v71, 0x3f803f80
    v_mov_b32 v72, 0x3f803f80
    v_mov_b32 v73, 0x3f803f80
    v_mov_b32 v74, 0x3f803f80
    v_mov_b32 v75, 0x3f803f80
    v_mov_b32 v76, 0x3f803f80
    v_mov_b32 v77, 0x3f803f80
    v_mov_b32 v78, 0x3f803f80
    v_mov_b32 v79, 0x3f803f80
    v_mov_b32 v80, 0x3f803f80
    v_mov_b32 v81, 0x3f803f80
    v_mov_b32 v82, 0x3f803f80
    v_mov_b32 v83, 0x3f803f80
    v_mov_b32 v84, 0x3f803f80
    v_mov_b32 v85, 0x3f803f80
    v_mov_b32 v86, 0x3f803f80
    v_mov_b32 v87, 0x3f803f80
    v_mov_b32 v88, 0x3f803f80
    v_mov_b32 v89, 0x3f803f80
    v_mov_b32 v90, 0x3f803f80
    v_mov_b32 v91, 0x3f803f80
    v_mov_b32 v92, 0x3f803f80
    v_mov_b32 v93, 0x3f803f80
    v_mov_b32 v94, 0x3f803f80
    v_mov_b32 v95, 0x3f803f80
    v_mov_b32 v96, 0x3f803f80
    v_mov_b32 v97, 0x3f803f80
    v_mov_b32 v98, 0x3f803f80
    v_mov_b32 v99, 0x3f803f80
    v_mov_b32 v100, 0x3f803f80
    v_mov_b32 v101, 0x3f803f80
    v_mov_b32 v102, 0x3f803f80
    v_mov_b32 v103, 0x3f803f80
    v_mov_b32 v104, 0x3f803f80
    v_mov_b32 v105, 0x3f803f80
    v_mov_b32 v106, 0x3f803f80
    v_mov_b32 v107, 0x3f803f80
    v_mov_b32 v108, 0x3f803f80
    v_mov_b32 v109, 0x3f803f80
    v_mov_b32 v110, 0x3f803f80
    v_mov_b32 v111, 0x3f803f80
    v_mov_b32 v112, 0x3f803f80
    v_mov_b32 v113, 0x3f803f80
    v_mov_b32 v114, 0x3f803f80
    v_mov_b32 v115, 0x3f803f80
    v_mov_b32 v116, 0x3f803f80
    v_mov_b32 v117, 0x3f803f80
    v_mov_b32 v118, 0x3f803f80
    v_mov_b32 v119, 0x3f803f80
    v_mov_b32 v120, 0x3f803f80
    v_mov_b32 v121, 0x3f803f80
    v_mov_b32 v122, 0x3f803f80
    v_mov_b32 v123, 0x3f803f80
    v_mov_b32 v124, 0x3f803f80
    v_mov_b32 v125, 0x3f803f80
    v_mov_b32 v126, 0x3f803f80
    v_mov_b32 v127, 0x3f803f80
    v_lshl_add_u32 v14, v15, 1, v14
    s_lshl_b32 s14, s5, 5
    v_lshl_add_u32 v14, v14, 1, s14
    s_waitcnt vmcnt(0)
    buffer_load_ushort v3, v14, s[48:51], 0 offen
    s_lshl_b32 s10, s9, 5
    s_and_b32 s15, s5, 7
    s_lshl_b32 s15, s15, 10
    s_lshr_b32 s13, s5, 3
    s_lshl_b32 s13, s13, 14
    s_add_u32 s15, s15, s13
    s_lshl_b32 s14, s6, 7
    s_add_u32 s79, s15, s14
    s_lshl_b32 s14, s6, 16
    s_lshl_b32 s13, s5, 6
    s_add_u32 s14, s14, 0x180000
    v_lshrrev_b32_e64 v21, 2, v0
    v_lshl_add_u32 v22, v21, 7, s13
    v_and_b32 v22, 0x7ff, v22
    v_lshl_add_u32 v21, v21, 11, v22
    v_and_b32_e64 v23, 3, v0
    v_lshl_add_u32 v21, v23, 4, v21
    v_add_u32 v21, s14, v21
    v_add_u32 v22, 0x8000, v21
    v_lshlrev_b32 v24, 4, v23
    v_bfe_u32 v25, v0, 4, 1
    v_lshl_add_u32 v24, v25, 3, v24
    v_lshrrev_b32 v25, 5, v0
    v_lshl_add_u32 v24, v25, 2, v24
    v_add_u32 v24, s79, v24
    v_mov_b32 v23, 0x10000000
    v_and_b32 v25, 12, v0
    v_cmp_eq_u32 vcc, 0, v25
    s_nop 1
    v_cndmask_b32 v24, v23, v24, vcc
    v_mov_b32 v23, 0x10000000
    v_cmp_gt_u32 vcc, 48, v0
    s_nop 1
    v_cndmask_b32 v23, v23, v22, vcc
    v_lshrrev_b32 v25, 3, v0
    v_lshlrev_b32_e64 v25, 7, v25
    v_lshl_add_u32 v25, v15, 3, v25
    v_add_u32 v25, s15, v25
    s_add_u32 s10, s10, 0x4000
    v_lshl_add_u32 v26, v15, 2, s10
    s_lshl_b32 s14, s5, 5
    v_lshl_add_u32 v27, v15, 2, s14
    v_mov_b32 v14, 0x10000000
    v_cmp_gt_u32 vcc, 8, v0
    s_nop 1
    v_cndmask_b32 v26, v14, v26, vcc
    v_cndmask_b32 v27, v14, v27, vcc
    s_lshl_b32 s14, s9, 11
    s_lshl_b32 s13, s5, 7
    v_lshl_add_u32 v28, v1, 6, s13
    v_and_b32 v28, 0x7ff, v28
    v_add_u32_e64 v28, s14, v28
    v_lshrrev_b32 v14, 5, v0
    v_lshl_add_u32 v28, v14, 5, v28
    s_lshl_b32 s14, s6, 11
    s_and_b32 s13, s5, 15
    s_lshl_b32 s13, s13, 4
    s_add_u32 s14, s14, s13
    s_lshr_b32 s13, s5, 4
    s_lshl_b32 s13, s13, 3
    s_add_u32 s14, s14, s13
    s_add_u32 s14, s14, 0x8000
    s_add_u32 s14, s14, 1024
    v_mov_b32 v14, s14
    v_mov_b32 v12, 0x10000000
    v_cmp_eq_u32 vcc, 28, v0
    s_nop 1
    v_cndmask_b32 v14, v12, v14, vcc
    s_mov_b32 s76, 0xffff0000
    s_mov_b32 s77, 0x05040100
    s_mov_b32 s78, 0x07060302
    s_getpc_b64 s[66:67]
L_pc_59:
    s_lshl_b32 s68, s5, 10
    s_add_u32 s68, s68, 512
    s_min_u32 s68, s68, L_code_end-interleave_layers__sliding_block_cached__glu_gated_glu__decode_kernel-388
    s_sub_u32 s66, s66, L_pc_59-interleave_layers__sliding_block_cached__glu_gated_glu__decode_kernel
    s_subb_u32 s67, s67, 0
    s_add_u32 s66, s66, s68
    s_addc_u32 s67, s67, 0
    s_load_dword s70, s[66:67], 0
    s_load_dword s71, s[66:67], 128
    s_load_dword s72, s[66:67], 256
    s_load_dword s73, s[66:67], 384
L_wa_60:
    ds_read_b128 v[4:7], v31 offset:3632
    s_waitcnt lgkmcnt(0)
    v_min_u32_e64 v4, v4, v5
    v_min3_u32 v4, v4, v6, v7
    s_nop 0
    v_readfirstlane_b32 s10, v4
    s_nop 0
    s_cmp_lg_u32 s10, 0
    s_cbranch_scc0 L_wad_61
    buffer_load_dword v250, v29, s[40:43], s7 offen sc1
    buffer_load_dword v250, v29, s[40:43], s7 offen offset:1024 sc1
    s_barrier
    ds_read_b32 v30, v31 offset:3584
    s_waitcnt lgkmcnt(0)
    v_readfirstlane_b32 s10, v30
    s_nop 0
    s_cmp_eq_u32 s10, 0
    s_cbranch_scc0 L_fallback
    s_barrier
    s_mov_b32 exec_lo, 0x0fffffff
    s_mov_b32 exec_hi, 0x0fffffff
    buffer_load_dwordx4 v[64:67], v13, s[44:47], s12 offen nt
    buffer_load_dwordx4 v[68:71], v13, s[52:55], s12 offen nt
    s_add_u32 s12, s12, 7168
    buffer_load_dwordx4 v[72:75], v13, s[44:47], s12 offen nt
    buffer_load_dwordx4 v[76:79], v13, s[52:55], s12 offen nt
    s_add_u32 s12, s12, 7168
    buffer_load_dwordx4 v[80:83], v13, s[44:47], s12 offen nt
    buffer_load_dwordx4 v[84:87], v13, s[52:55], s12 offen nt
    s_add_u32 s12, s12, 7168
    buffer_load_dwordx4 v[88:91], v13, s[44:47], s12 offen nt
    buffer_load_dwordx4 v[92:95], v13, s[52:55], s12 offen nt
    s_add_u32 s12, s12, 7168
    buffer_load_dwordx4 v[96:99], v13, s[44:47], s12 offen nt
    buffer_load_dwordx4 v[100:103], v13, s[52:55], s12 offen nt
    s_add_u32 s12, s12, 7168
    buffer_load_dwordx4 v[104:107], v13, s[44:47], s12 offen nt
    buffer_load_dwordx4 v[108:111], v13, s[52:55], s12 offen nt
    s_add_u32 s12, s12, 7168
    buffer_load_dwordx4 v[112:115], v13, s[44:47], s12 offen nt
    buffer_load_dwordx4 v[116:119], v13, s[52:55], s12 offen nt
    s_add_u32 s12, s12, 7168
    buffer_load_dwordx4 v[120:123], v13, s[44:47], s12 offen nt
    buffer_load_dwordx4 v[124:127], v13, s[52:55], s12 offen nt
    s_mov_b64 exec, -1
    s_waitcnt vmcnt(0)
    v_lshlrev_b32_e64 v20, 16, v3
    v_permlane32_swap_b32 v64, v68
    v_permlane32_swap_b32 v65, v69
    v_permlane32_swap_b32 v66, v70
    v_permlane32_swap_b32 v67, v71
    v_perm_b32 v128, v68, v64, s77
    v_perm_b32 v129, v68, v64, s78
    v_perm_b32 v130, v69, v65, s77
    v_perm_b32 v131, v69, v65, s78
    v_perm_b32 v132, v70, v66, s77
    v_perm_b32 v133, v70, v66, s78
    v_perm_b32 v134, v71, v67, s77
    v_perm_b32 v135, v71, v67, s78
    v_permlane32_swap_b32 v72, v76
    v_permlane32_swap_b32 v73, v77
    v_permlane32_swap_b32 v74, v78
    v_permlane32_swap_b32 v75, v79
    v_perm_b32 v136, v76, v72, s77
    v_perm_b32 v137, v76, v72, s78
    v_perm_b32 v138, v77, v73, s77
    v_perm_b32 v139, v77, v73, s78
    v_perm_b32 v140, v78, v74, s77
    v_perm_b32 v141, v78, v74, s78
    v_perm_b32 v142, v79, v75, s77
    v_perm_b32 v143, v79, v75, s78
    v_permlane32_swap_b32 v80, v84
    v_permlane32_swap_b32 v81, v85
    v_permlane32_swap_b32 v82, v86
    v_permlane32_swap_b32 v83, v87
    v_perm_b32 v144, v84, v80, s77
    v_perm_b32 v145, v84, v80, s78
    v_perm_b32 v146, v85, v81, s77
    v_perm_b32 v147, v85, v81, s78
    v_perm_b32 v148, v86, v82, s77
    v_perm_b32 v149, v86, v82, s78
    v_perm_b32 v150, v87, v83, s77
    v_perm_b32 v151, v87, v83, s78
    v_permlane32_swap_b32 v88, v92
    v_permlane32_swap_b32 v89, v93
    v_permlane32_swap_b32 v90, v94
    v_permlane32_swap_b32 v91, v95
    v_perm_b32 v152, v92, v88, s77
    v_perm_b32 v153, v92, v88, s78
    v_perm_b32 v154, v93, v89, s77
    v_perm_b32 v155, v93, v89, s78
    v_perm_b32 v156, v94, v90, s77
    v_perm_b32 v157, v94, v90, s78
    v_perm_b32 v158, v95, v91, s77
    v_perm_b32 v159, v95, v91, s78
    v_permlane32_swap_b32 v96, v100
    v_permlane32_swap_b32 v97, v101
    v_permlane32_swap_b32 v98, v102
    v_permlane32_swap_b32 v99, v103
    v_perm_b32 v160, v100, v96, s77
    v_perm_b32 v161, v100, v96, s78
    v_perm_b32 v162, v101, v97, s77
    v_perm_b32 v163, v101, v97, s78
    v_perm_b32 v164, v102, v98, s77
    v_perm_b32 v165, v102, v98, s78
    v_perm_b32 v166, v103, v99, s77
    v_perm_b32 v167, v103, v99, s78
    v_permlane32_swap_b32 v104, v108
    v_permlane32_swap_b32 v105, v109
    v_permlane32_swap_b32 v106, v110
    v_permlane32_swap_b32 v107, v111
    v_perm_b32 v168, v108, v104, s77
    v_perm_b32 v169, v108, v104, s78
    v_perm_b32 v170, v109, v105, s77
    v_perm_b32 v171, v109, v105, s78
    v_perm_b32 v172, v110, v106, s77
    v_perm_b32 v173, v110, v106, s78
    v_perm_b32 v174, v111, v107, s77
    v_perm_b32 v175, v111, v107, s78
    v_permlane32_swap_b32 v112, v116
    v_permlane32_swap_b32 v113, v117
    v_permlane32_swap_b32 v114, v118
    v_permlane32_swap_b32 v115, v119
    v_perm_b32 v176, v116, v112, s77
    v_perm_b32 v177, v116, v112, s78
    v_perm_b32 v178, v117, v113, s77
    v_perm_b32 v179, v117, v113, s78
    v_perm_b32 v180, v118, v114, s77
    v_perm_b32 v181, v118, v114, s78
    v_perm_b32 v182, v119, v115, s77
    v_perm_b32 v183, v119, v115, s78
    v_permlane32_swap_b32 v120, v124
    v_permlane32_swap_b32 v121, v125
    v_permlane32_swap_b32 v122, v126
    v_permlane32_swap_b32 v123, v127
    v_perm_b32 v184, v124, v120, s77
    v_perm_b32 v185, v124, v120, s78
    v_perm_b32 v186, v125, v121, s77
    v_perm_b32 v187, v125, v121, s78
    v_perm_b32 v188, v126, v122, s77
    v_perm_b32 v189, v126, v122, s78
    v_perm_b32 v190, v127, v123, s77
    v_perm_b32 v191, v127, v123, s78
    s_mov_b32 s66, 0x3f803f80
    s_mov_b32 s67, 0x3f803f80
    s_mov_b32 s68, 0x3f803f80
    s_mov_b32 s69, 0x3f803f80
    s_mov_b32 s70, 0x3f803f80
    s_mov_b32 s71, 0x3f803f80
    s_mov_b32 s72, 0x3f803f80
    s_mov_b32 s73, 0x3f803f80
    s_add_u32 s10, s7, 0x200000
    s_cmp_lg_u32 s7, 0
    v_dot2_f32_bf16 v4, v128, s66, 0
    v_dot2_f32_bf16 v8, v132, s66, 0
    v_dot2_f32_bf16 v5, v129, s66, 0
    v_dot2_f32_bf16 v6, v130, s66, 0
    v_dot2_f32_bf16 v7, v131, s66, 0
    v_dot2_f32_bf16 v9, v133, s66, 0
    v_dot2_f32_bf16 v10, v134, s66, 0
    v_dot2_f32_bf16 v11, v135, s66, 0
    v_dot2c_f32_bf16 v4, s67, v136
    v_dot2c_f32_bf16 v8, s67, v140
    v_dot2c_f32_bf16 v5, s67, v137
    v_dot2c_f32_bf16 v6, s67, v138
    v_dot2c_f32_bf16 v7, s67, v139
    v_dot2c_f32_bf16 v9, s67, v141
    v_dot2c_f32_bf16 v10, s67, v142
    v_dot2c_f32_bf16 v11, s67, v143
    v_dot2c_f32_bf16 v4, s68, v144
    v_dot2c_f32_bf16 v8, s68, v148
    v_dot2c_f32_bf16 v5, s68, v145
    v_dot2c_f32_bf16 v6, s68, v146
    v_dot2c_f32_bf16 v7, s68, v147
    v_dot2c_f32_bf16 v9, s68, v149
    v_dot2c_f32_bf16 v10, s68, v150
    v_dot2c_f32_bf16 v11, s68, v151
    v_dot2c_f32_bf16 v4, s69, v152
    v_dot2c_f32_bf16 v8, s69, v156
    v_dot2c_f32_bf16 v5, s69, v153
    v_dot2c_f32_bf16 v6, s69, v154
    v_dot2c_f32_bf16 v7, s69, v155
    v_dot2c_f32_bf16 v9, s69, v157
    v_dot2c_f32_bf16 v10, s69, v158
    v_dot2c_f32_bf16 v11, s69, v159
    v_dot2c_f32_bf16 v4, s70, v160
    v_dot2c_f32_bf16 v8, s70, v164
    v_dot2c_f32_bf16 v5, s70, v161
    v_dot2c_f32_bf16 v6, s70, v162
    v_dot2c_f32_bf16 v7, s70, v163
    v_dot2c_f32_bf16 v9, s70, v165
    v_dot2c_f32_bf16 v10, s70, v166
    v_dot2c_f32_bf16 v11, s70, v167
    v_dot2c_f32_bf16 v4, s71, v168
    v_dot2c_f32_bf16 v8, s71, v172
    v_dot2c_f32_bf16 v5, s71, v169
    v_dot2c_f32_bf16 v6, s71, v170
    v_dot2c_f32_bf16 v7, s71, v171
    v_dot2c_f32_bf16 v9, s71, v173
    v_dot2c_f32_bf16 v10, s71, v174
    v_dot2c_f32_bf16 v11, s71, v175
    v_dot2c_f32_bf16 v4, s72, v176
    v_dot2c_f32_bf16 v8, s72, v180
    v_dot2c_f32_bf16 v5, s72, v177
    v_dot2c_f32_bf16 v6, s72, v178
    v_dot2c_f32_bf16 v7, s72, v179
    v_dot2c_f32_bf16 v9, s72, v181
    v_dot2c_f32_bf16 v10, s72, v182
    v_dot2c_f32_bf16 v11, s72, v183
    v_dot2c_f32_bf16 v4, s73, v184
    v_dot2c_f32_bf16 v8, s73, v188
    v_dot2c_f32_bf16 v5, s73, v185
    v_dot2c_f32_bf16 v6, s73, v186
    v_dot2c_f32_bf16 v7, s73, v187
    v_dot2c_f32_bf16 v9, s73, v189
    v_dot2c_f32_bf16 v10, s73, v190
    v_dot2c_f32_bf16 v11, s73, v191
    v_and_or_b32 v4, v4, -16, 14
    v_and_or_b32 v8, v8, -16, 14
    s_cbranch_scc1 L_slow_62
    buffer_store_dwordx4 v[4:7], v28, s[40:43], s10 offen
    buffer_store_dwordx4 v[8:11], v28, s[40:43], s10 offen offset:16
L_pub_63:
    v_mov_b32_e64 v30, 1
    ds_write_b32 v31, v30 offset:3596
L_wf_64:
    ds_read_b32 v30, v31 offset:3600
    s_waitcnt lgkmcnt(0)
    v_readfirstlane_b32 s10, v30
    s_nop 0
    s_cmp_ge_u32 s10, 1
    s_cbranch_scc0 L_wfr_65
    s_add_u32 s10, s7, 0x40000
    s_add_u32 s11, s10, 8192
    s_mov_b32 s65, 0
    s_nop 15
    s_nop 15
    s_nop 15
    s_nop 15
    s_nop 15
    s_nop 15
    s_nop 15
    s_nop 15
    s_nop 15
    s_nop 15
    buffer_load_dwordx4 v[32:35], v21, s[40:43], s7 offen sc1
    buffer_load_dwordx4 v[36:39], v22, s[40:43], s7 offen sc1
    s_nop 15
    s_nop 15
L_gp_66:
    buffer_load_dwordx4 v[40:43], v21, s[40:43], s7 offen sc1
    buffer_load_dwordx4 v[44:47], v22, s[40:43], s7 offen sc1
    s_add_u32 s65, s65, 1
    s_cmp_lt_u32 s65, s3
    s_cbranch_scc0 L_gz_70
    s_waitcnt vmcnt(2)
    v_bitop3_b32 v12, v32, v36, 1 bitop3:0xa8
    v_cmp_ne_u32_e64 vcc, 0, v12
    v_add_f32 v4, v32, v36
    v_add_f32 v5, v33, v37
    v_add_f32 v6, v34, v38
    v_add_f32 v7, v35, v39
    v_permlane32_swap_b32 v4, v5
    s_cbranch_vccz L_gd_67
    buffer_load_dwordx4 v[32:35], v21, s[40:43], s7 offen sc1
    buffer_load_dwordx4 v[36:39], v22, s[40:43], s7 offen sc1
    s_waitcnt vmcnt(2)
    v_bitop3_b32 v12, v40, v44, 1 bitop3:0xa8
    v_cmp_ne_u32 vcc, 0, v12
    v_add_f32 v4, v40, v44
    v_add_f32 v5, v41, v45
    v_add_f32 v6, v42, v46
    v_add_f32 v7, v43, v47
    v_permlane32_swap_b32 v4, v5
    s_cbranch_vccnz L_gp_66
L_gz_70:
L_gd_67:
    v_permlane32_swap_b32 v6, v7
    v_add_f32 v4, v4, v5
    v_add_f32 v6, v6, v7
    v_mov_b32 v30, 1
    ds_write_b32 v31, v30 offset:3604
    v_permlane16_swap_b32 v4, v6
    v_add_f32 v4, v4, v6
    s_nop 1
    v_add_f32_dpp v4, v4, v4 row_ror:4 row_mask:0xf bank_mask:0xf
    s_nop 1
    v_add_f32_dpp v4, v4, v4 row_ror:8 row_mask:0xf bank_mask:0xf
    v_and_or_b32 v4, v4, -16, 14
    buffer_store_dword v4, v24, s[40:43], s10 offen sc1
    buffer_store_dword v4, v24, s[40:43], s11 offen sc1
L_wf_72:
    ds_read_b32 v30, v31 offset:3592
    s_waitcnt lgkmcnt(0)
    v_readfirstlane_b32 s10, v30
    s_nop 0
    s_cmp_ge_u32 s10, 1
    s_cbranch_scc0 L_wfr_73
    s_cmp_eq_u32 s10, 1
    s_cbranch_scc1 L_ver_74
    v_mov_b32 v30, 256
    ds_write_b32 v31, v30 offset:3604
    s_branch L_r_bq2
L_ver_74:
L_wf_75:
    ds_read_b32 v30, v31 offset:3648
    s_waitcnt lgkmcnt(0)
    v_readfirstlane_b32 s10, v30
    s_nop 0
    s_cmp_ge_u32 s10, 1
    s_cbranch_scc0 L_wfr_76
    s_sub_u32 s10, s10, 1
    s_lshl_b32 s10, s10, 13
    v_add_u32 v25, s10, v25
    s_add_u32 s10, s7, 0x40000
    s_mov_b32 s65, 0
    s_nop 15
    s_nop 15
    s_nop 15
    s_nop 15
    s_nop 15
    s_nop 15
    buffer_load_dwordx2 v[56:57], v25, s[40:43], s10 offen sc1
    s_nop 15
    s_nop 15
    s_nop 15
    buffer_load_dwordx2 v[58:59], v25, s[40:43], s10 offen sc1
    s_nop 15
    s_nop 15
    s_nop 15
L_gp_77:
    buffer_load_dwordx2 v[60:61], v25, s[40:43], s10 offen sc1
    s_add_u32 s65, s65, 1
    s_cmp_lt_u32 s65, s3
    s_cbranch_scc0 L_gz_82
    s_waitcnt vmcnt(2)
    v_bitop3_b32 v6, v56, v57, 1 bitop3:0xa8
    v_cmp_ne_u32 vcc, 0, v6
    v_permlane32_swap_b32 v56, v57
    v_add_f32 v4, v56, v57
    v_mov_b32 v5, v4
    s_nop 0
    s_cbranch_vccz L_gd_78
    buffer_load_dwordx2 v[56:57], v25, s[40:43], s10 offen sc1
    s_waitcnt vmcnt(2)
    v_bitop3_b32 v6, v58, v59, 1 bitop3:0xa8
    v_cmp_ne_u32 vcc, 0, v6
    v_permlane32_swap_b32 v58, v59
    v_add_f32 v4, v58, v59
    v_mov_b32 v5, v4
    s_nop 0
    s_cbranch_vccz L_gd_78
    buffer_load_dwordx2 v[58:59], v25, s[40:43], s10 offen sc1
    s_waitcnt vmcnt(2)
    v_bitop3_b32 v6, v60, v61, 1 bitop3:0xa8
    v_cmp_ne_u32 vcc, 0, v6
    v_permlane32_swap_b32 v60, v61
    v_add_f32 v4, v60, v61
    v_mov_b32 v5, v4
    s_nop 0
    s_cbranch_vccnz L_gp_77
L_gz_82:
L_gd_78:
    v_permlane16_swap_b32 v4, v5
    v_add_f32 v4, v4, v5
    v_mov_b32 v30, 2
    ds_write_b32 v31, v30 offset:3604
    v_add_f32_dpp v4, v4, v4 row_ror:8 row_mask:0xf bank_mask:0xf
    v_cvt_pk_bf16_f32 v4, 0, v4
    v_add_f32_e64 v4, v20, v4
    v_cvt_pk_bf16_f32 v4, v4, v4
    v_mov_b32 v5, v4
    v_and_b32 v20, s76, v4
    s_add_u32 s10, s7, 0x100000
    v_permlane32_swap_b32 v4, v5
    v_bfi_b32 v4, s76, v5, v4
    s_cmp_lg_u32 s7, 0
    v_readlane_b32 s66, v4, 0
    v_readlane_b32 s67, v4, 1
    v_readlane_b32 s68, v4, 2
    v_readlane_b32 s69, v4, 3
    v_readlane_b32 s70, v4, 4
    v_readlane_b32 s71, v4, 5
    v_readlane_b32 s72, v4, 6
    v_readlane_b32 s73, v4, 7
    v_dot2_f32_bf16 v12, v4, v4, 0
    v_dot2_f32_bf16 v4, v128, s66, 0
    v_dot2_f32_bf16 v8, v132, s66, 0
    v_dot2_f32_bf16 v5, v129, s66, 0
    v_dot2_f32_bf16 v6, v130, s66, 0
    v_dot2_f32_bf16 v7, v131, s66, 0
    v_dot2_f32_bf16 v9, v133, s66, 0
    v_dot2_f32_bf16 v10, v134, s66, 0
    v_dot2_f32_bf16 v11, v135, s66, 0
    v_add_f32_dpp v12, v12, v12 quad_perm:[1,0,3,2] row_mask:0xf bank_mask:0xf
    v_dot2c_f32_bf16 v4, s67, v136
    v_dot2c_f32_bf16 v8, s67, v140
    v_dot2c_f32_bf16 v5, s67, v137
    v_dot2c_f32_bf16 v6, s67, v138
    v_dot2c_f32_bf16 v7, s67, v139
    v_dot2c_f32_bf16 v9, s67, v141
    v_dot2c_f32_bf16 v10, s67, v142
    v_dot2c_f32_bf16 v11, s67, v143
    v_add_f32_dpp v12, v12, v12 quad_perm:[2,3,0,1] row_mask:0xf bank_mask:0xf
    v_dot2c_f32_bf16 v4, s68, v144
    v_dot2c_f32_bf16 v8, s68, v148
    v_dot2c_f32_bf16 v5, s68, v145
    v_dot2c_f32_bf16 v6, s68, v146
    v_dot2c_f32_bf16 v7, s68, v147
    v_dot2c_f32_bf16 v9, s68, v149
    v_dot2c_f32_bf16 v10, s68, v150
    v_dot2c_f32_bf16 v11, s68, v151
    v_add_f32_dpp v12, v12, v12 row_half_mirror row_mask:0xf bank_mask:0xf
    v_dot2c_f32_bf16 v4, s69, v152
    v_dot2c_f32_bf16 v8, s69, v156
    v_dot2c_f32_bf16 v5, s69, v153
    v_dot2c_f32_bf16 v6, s69, v154
    v_dot2c_f32_bf16 v7, s69, v155
    v_dot2c_f32_bf16 v9, s69, v157
    v_dot2c_f32_bf16 v10, s69, v158
    v_dot2c_f32_bf16 v11, s69, v159
    v_dot2c_f32_bf16 v4, s70, v160
    v_dot2c_f32_bf16 v8, s70, v164
    v_dot2c_f32_bf16 v5, s70, v161
    v_dot2c_f32_bf16 v6, s70, v162
    v_dot2c_f32_bf16 v7, s70, v163
    v_dot2c_f32_bf16 v9, s70, v165
    v_dot2c_f32_bf16 v10, s70, v166
    v_dot2c_f32_bf16 v11, s70, v167
    v_dot2c_f32_bf16 v4, s71, v168
    v_dot2c_f32_bf16 v8, s71, v172
    v_dot2c_f32_bf16 v5, s71, v169
    v_dot2c_f32_bf16 v6, s71, v170
    v_dot2c_f32_bf16 v7, s71, v171
    v_dot2c_f32_bf16 v9, s71, v173
    v_dot2c_f32_bf16 v10, s71, v174
    v_dot2c_f32_bf16 v11, s71, v175
    v_dot2c_f32_bf16 v4, s72, v176
    v_dot2c_f32_bf16 v8, s72, v180
    v_dot2c_f32_bf16 v5, s72, v177
    v_dot2c_f32_bf16 v6, s72, v178
    v_dot2c_f32_bf16 v7, s72, v179
    v_dot2c_f32_bf16 v9, s72, v181
    v_dot2c_f32_bf16 v10, s72, v182
    v_dot2c_f32_bf16 v11, s72, v183
    v_dot2c_f32_bf16 v4, s73, v184
    v_dot2c_f32_bf16 v8, s73, v188
    v_dot2c_f32_bf16 v5, s73, v185
    v_dot2c_f32_bf16 v6, s73, v186
    v_dot2c_f32_bf16 v7, s73, v187
    v_dot2c_f32_bf16 v9, s73, v189
    v_dot2c_f32_bf16 v10, s73, v190
    v_dot2c_f32_bf16 v11, s73, v191
    v_and_or_b32 v12, v12, -16, 14
    v_and_or_b32 v4, v4, -16, 12
    v_and_or_b32 v8, v8, -16, 12
    s_cbranch_scc1 L_slow_83
    buffer_store_dwordx4 v[4:7], v28, s[40:43], s10 offen
    buffer_store_dwordx4 v[8:11], v28, s[40:43], s10 offen offset:16
    v_mov_b32 v13, v5
    buffer_store_dwordx2 v[12:13], v14, s[40:43], s7 offen
L_pub_84:
    s_mov_b32 s14, 0x50000
    buffer_load_dwordx2 v[252:253], v25, s[40:43], s14 offen sc1
    s_cmp_ge_u32 s5, 28
    s_cbranch_scc1 L_nof_85
L_wf_86:
    ds_read_b32 v30, v31 offset:3608
    s_waitcnt lgkmcnt(0)
    v_readfirstlane_b32 s10, v30
    s_nop 0
    s_cmp_ge_u32 s10, 1
    s_cbranch_scc0 L_wfr_87
L_nof_85:
    s_add_u32 s10, s7, 0x50000
    s_add_u32 s11, s10, 8192
    s_mov_b32 s65, 0
    s_nop 0
    s_nop 15
    s_nop 15
    s_nop 15
    s_nop 15
    s_nop 15
    s_nop 15
    s_nop 15
    buffer_load_dwordx4 v[32:35], v21, s[40:43], s7 offen sc1
    buffer_load_dwordx4 v[36:39], v23, s[40:43], s7 offen sc1
    s_nop 15
    s_nop 15
L_gp_88:
    buffer_load_dwordx4 v[40:43], v21, s[40:43], s7 offen sc1
    buffer_load_dwordx4 v[44:47], v23, s[40:43], s7 offen sc1
    s_add_u32 s65, s65, 1
    s_cmp_lt_u32 s65, s3
    s_cbranch_scc0 L_gz_92
    s_waitcnt vmcnt(2)
    v_bitop3_b32 v12, v32, v36, 2 bitop3:0xa8
    v_cmp_ne_u32 vcc, 0, v12
    v_add_f32 v4, v32, v36
    v_add_f32 v5, v33, v37
    v_add_f32 v6, v34, v38
    v_add_f32_e64 v7, v35, v39
    v_permlane32_swap_b32 v4, v5
    s_cbranch_vccz L_gd_89
    buffer_load_dwordx4 v[32:35], v21, s[40:43], s7 offen sc1
    buffer_load_dwordx4 v[36:39], v23, s[40:43], s7 offen sc1
    s_waitcnt vmcnt(2)
    v_bitop3_b32 v12, v40, v44, 2 bitop3:0xa8
    v_cmp_ne_u32 vcc, 0, v12
    v_add_f32 v4, v40, v44
    v_add_f32 v5, v41, v45
    v_add_f32 v6, v42, v46
    v_add_f32 v7, v43, v47
    v_permlane32_swap_b32 v4, v5
    s_cbranch_vccnz L_gp_88
L_gz_92:
L_gd_89:
    v_permlane32_swap_b32 v6, v7
    v_add_f32 v4, v4, v5
    v_add_f32 v6, v6, v7
    s_nop 1
    v_permlane16_swap_b32 v4, v6
    v_add_f32 v4, v4, v6
    s_nop 1
    v_add_f32_dpp v4, v4, v4 row_ror:4 row_mask:0xf bank_mask:0xf
    s_nop 1
    v_add_f32_dpp v4, v4, v4 row_ror:8 row_mask:0xf bank_mask:0xf
    v_and_or_b32 v4, v4, -16, 14
    buffer_store_dword v4, v24, s[40:43], s10 offen sc1
    buffer_store_dword v4, v24, s[40:43], s11 offen sc1
    s_mov_b32 s65, 0
    s_nop 15
    s_nop 15
    s_nop 15
    s_nop 15
    s_nop 15
    s_nop 15
    buffer_load_dwordx2 v[56:57], v25, s[40:43], s10 offen sc1
    s_nop 15
    s_nop 15
    s_nop 15
    buffer_load_dwordx2 v[58:59], v25, s[40:43], s10 offen sc1
    s_nop 15
    s_nop 15
    s_nop 15
L_gp_94:
    buffer_load_dwordx2 v[60:61], v25, s[40:43], s10 offen sc1
    s_add_u32 s65, s65, 1
    s_cmp_lt_u32 s65, s3
    s_cbranch_scc0 L_gz_99
    s_waitcnt vmcnt(2)
    v_bitop3_b32 v6, v56, v57, 1 bitop3:0xa8
    v_cmp_ne_u32 vcc, 0, v6
    v_permlane32_swap_b32 v56, v57
    v_add_f32 v4, v56, v57
    v_mov_b32 v5, v4
    s_nop 0
    s_cbranch_vccz L_gd_95
    buffer_load_dwordx2 v[56:57], v25, s[40:43], s10 offen sc1
    s_waitcnt vmcnt(2)
    v_bitop3_b32 v6, v58, v59, 1 bitop3:0xa8
    v_cmp_ne_u32 vcc, 0, v6
    v_permlane32_swap_b32 v58, v59
    v_add_f32 v4, v58, v59
    v_mov_b32 v5, v4
    s_nop 0
    s_cbranch_vccz L_gd_95
    buffer_load_dwordx2 v[58:59], v25, s[40:43], s10 offen sc1
    s_waitcnt vmcnt(2)
    v_bitop3_b32 v6, v60, v61, 1 bitop3:0xa8
    v_cmp_ne_u32 vcc, 0, v6
    v_permlane32_swap_b32 v60, v61
    v_add_f32 v4, v60, v61
    v_mov_b32 v5, v4
    s_nop 0
    s_cbranch_vccnz L_gp_94
L_gz_99:
L_gd_95:
    v_permlane16_swap_b32 v4, v5
    v_add_f32 v4, v4, v5
    v_mov_b32 v30, 3
    ds_write_b32 v31, v30 offset:3604
    v_add_f32_dpp v4, v4, v4 row_ror:8 row_mask:0xf bank_mask:0xf
    v_cvt_pk_bf16_f32 v4, 0, v4
    v_add_f32_e64 v4, v20, v4
    v_cvt_pk_bf16_f32 v4, v4, v4
    v_mov_b32 v5, v4
    v_and_b32 v20, s76, v4
    s_nop 0
    v_permlane32_swap_b32 v4, v5
    v_bfi_b32 v4, s76, v5, v4
    s_cmp_lg_u32 s7, 0
    v_min_u32 v4, -2, v4
    s_cbranch_scc1 L_slow_100
    buffer_store_dword v4, v26, s[40:43], s7 offen
L_pub_101:
L_r_bq2:
    s_barrier
    s_barrier
    ds_read_b32 v30, v31 offset:3584
    s_waitcnt lgkmcnt(0)
    v_readfirstlane_b32 s10, v30
    s_nop 0
    s_cmp_eq_u32 s10, 0
    s_cbranch_scc0 L_fallback
    s_barrier
L_wf_102:
    ds_read_b32 v30, v31 offset:3600
    s_waitcnt lgkmcnt(0)
    v_readfirstlane_b32 s10, v30
    s_nop 0
    s_cmp_ge_u32 s10, 2
    s_cbranch_scc0 L_wfr_103
    s_add_u32 s10, s7, 0x40000
    s_add_u32 s11, s10, 8192
    s_mov_b32 s65, 0
    s_nop 15
    s_nop 15
    s_nop 15
    s_nop 15
    s_nop 15
    s_nop 15
    s_nop 15
    s_nop 15
    s_nop 15
    s_nop 0
    s_nop 15
    buffer_load_dwordx4 v[32:35], v21, s[40:43], s7 offen sc1
    buffer_load_dwordx4 v[36:39], v22, s[40:43], s7 offen sc1
    s_nop 15
    s_nop 15
L_gp_104:
    buffer_load_dwordx4 v[40:43], v21, s[40:43], s7 offen sc1
    buffer_load_dwordx4 v[44:47], v22, s[40:43], s7 offen sc1
    s_add_u32 s65, s65, 1
    s_cmp_lt_u32 s65, s3
    s_cbranch_scc0 L_gz_108
    s_waitcnt vmcnt(2)
    v_bitop3_b32 v12, v32, v36, 4 bitop3:0xa8
    v_cmp_ne_u32_e64 vcc, 0, v12
    v_add_f32 v4, v32, v36
    v_add_f32 v5, v33, v37
    v_add_f32 v6, v34, v38
    v_add_f32 v7, v35, v39
    v_permlane32_swap_b32 v4, v5
    s_cbranch_vccz L_gd_105
    buffer_load_dwordx4 v[32:35], v21, s[40:43], s7 offen sc1
    buffer_load_dwordx4 v[36:39], v22, s[40:43], s7 offen sc1
    s_waitcnt vmcnt(2)
    v_bitop3_b32 v12, v40, v44, 4 bitop3:0xa8
    v_cmp_ne_u32 vcc, 0, v12
    v_add_f32 v4, v40, v44
    v_add_f32 v5, v41, v45
    v_add_f32 v6, v42, v46
    v_add_f32 v7, v43, v47
    v_permlane32_swap_b32 v4, v5
    s_cbranch_vccnz L_gp_104
L_gz_108:
L_gd_105:
    v_permlane32_swap_b32 v6, v7
    v_add_f32 v4, v4, v5
    v_add_f32 v6, v6, v7
    s_nop 1
    v_permlane16_swap_b32 v4, v6
    v_add_f32 v4, v4, v6
    s_nop 1
    v_add_f32_dpp v4, v4, v4 row_ror:4 row_mask:0xf bank_mask:0xf
    s_nop 1
    v_add_f32_dpp v4, v4, v4 row_ror:8 row_mask:0xf bank_mask:0xf
    v_and_or_b32 v4, v4, -16, 12
    buffer_store_dword v4, v24, s[40:43], s10 offen sc1
    buffer_store_dword v4, v24, s[40:43], s11 offen sc1
    s_mov_b32 s65, 0
    s_nop 15
    s_nop 15
    s_nop 15
    s_nop 15
    s_nop 15
    s_nop 15
    buffer_load_dwordx2 v[56:57], v25, s[40:43], s10 offen sc1
    s_nop 15
    s_nop 15
    s_nop 15
    buffer_load_dwordx2 v[58:59], v25, s[40:43], s10 offen sc1
    s_nop 15
    s_nop 15
    s_nop 15
L_gp_110:
    buffer_load_dwordx2 v[60:61], v25, s[40:43], s10 offen sc1
    s_add_u32 s65, s65, 1
    s_cmp_lt_u32 s65, s3
    s_cbranch_scc0 L_gz_115
    s_waitcnt vmcnt(2)
    v_bitop3_b32 v6, v56, v57, 2 bitop3:0xa8
    v_cmp_ne_u32 vcc, 0, v6
    v_permlane32_swap_b32 v56, v57
    v_add_f32 v4, v56, v57
    v_mov_b32 v5, v4
    s_nop 0
    s_cbranch_vccz L_gd_111
    buffer_load_dwordx2 v[56:57], v25, s[40:43], s10 offen sc1
    s_waitcnt vmcnt(2)
    v_bitop3_b32 v6, v58, v59, 2 bitop3:0xa8
    v_cmp_ne_u32 vcc, 0, v6
    v_permlane32_swap_b32 v58, v59
    v_add_f32 v4, v58, v59
    v_mov_b32 v5, v4
    s_nop 0
    s_cbranch_vccz L_gd_111
    buffer_load_dwordx2 v[58:59], v25, s[40:43], s10 offen sc1
    s_waitcnt vmcnt(2)
    v_bitop3_b32 v6, v60, v61, 2 bitop3:0xa8
    v_cmp_ne_u32 vcc, 0, v6
    v_permlane32_swap_b32 v60, v61
    v_add_f32 v4, v60, v61
    v_mov_b32 v5, v4
    s_nop 0
    s_cbranch_vccnz L_gp_110
L_gz_115:
L_gd_111:
    v_permlane16_swap_b32 v4, v5
    v_add_f32 v4, v4, v5
    v_mov_b32 v30, 4
    ds_write_b32 v31, v30 offset:3604
    v_add_f32_dpp v4, v4, v4 row_ror:8 row_mask:0xf bank_mask:0xf
    v_cvt_pk_bf16_f32 v4, 0, v4
    v_add_f32_e64 v4, v20, v4
    v_cvt_pk_bf16_f32 v4, v4, v4
    v_mov_b32 v5, v4
    v_and_b32 v20, s76, v4
    s_add_u32 s10, s7, 0x100000
    v_permlane32_swap_b32 v4, v5
    v_bfi_b32 v4, s76, v5, v4
    s_cmp_lg_u32 s7, 0
    v_readlane_b32 s66, v4, 0
    v_readlane_b32 s67, v4, 1
    v_readlane_b32 s68, v4, 2
    v_readlane_b32 s69, v4, 3
    v_readlane_b32 s70, v4, 4
    v_readlane_b32 s71, v4, 5
    v_readlane_b32 s72, v4, 6
    v_readlane_b32 s73, v4, 7
    v_dot2_f32_bf16 v12, v4, v4, 0
    v_dot2_f32_bf16 v4, v128, s66, 0
    v_dot2_f32_bf16 v8, v132, s66, 0
    v_dot2_f32_bf16 v5, v129, s66, 0
    v_dot2_f32_bf16 v6, v130, s66, 0
    v_dot2_f32_bf16 v7, v131, s66, 0
    v_dot2_f32_bf16 v9, v133, s66, 0
    v_dot2_f32_bf16 v10, v134, s66, 0
    v_dot2_f32_bf16 v11, v135, s66, 0
    v_add_f32_dpp v12, v12, v12 quad_perm:[1,0,3,2] row_mask:0xf bank_mask:0xf
    v_dot2c_f32_bf16 v4, s67, v136
    v_dot2c_f32_bf16 v8, s67, v140
    v_dot2c_f32_bf16 v5, s67, v137
    v_dot2c_f32_bf16 v6, s67, v138
    v_dot2c_f32_bf16 v7, s67, v139
    v_dot2c_f32_bf16 v9, s67, v141
    v_dot2c_f32_bf16 v10, s67, v142
    v_dot2c_f32_bf16 v11, s67, v143
    v_add_f32_dpp v12, v12, v12 quad_perm:[2,3,0,1] row_mask:0xf bank_mask:0xf
    v_dot2c_f32_bf16 v4, s68, v144
    v_dot2c_f32_bf16 v8, s68, v148
    v_dot2c_f32_bf16 v5, s68, v145
    v_dot2c_f32_bf16 v6, s68, v146
    v_dot2c_f32_bf16 v7, s68, v147
    v_dot2c_f32_bf16 v9, s68, v149
    v_dot2c_f32_bf16 v10, s68, v150
    v_dot2c_f32_bf16 v11, s68, v151
    v_add_f32_dpp v12, v12, v12 row_half_mirror row_mask:0xf bank_mask:0xf
    v_dot2c_f32_bf16 v4, s69, v152
    v_dot2c_f32_bf16 v8, s69, v156
    v_dot2c_f32_bf16 v5, s69, v153
    v_dot2c_f32_bf16 v6, s69, v154
    v_dot2c_f32_bf16 v7, s69, v155
    v_dot2c_f32_bf16 v9, s69, v157
    v_dot2c_f32_bf16 v10, s69, v158
    v_dot2c_f32_bf16 v11, s69, v159
    v_dot2c_f32_bf16 v4, s70, v160
    v_dot2c_f32_bf16 v8, s70, v164
    v_dot2c_f32_bf16 v5, s70, v161
    v_dot2c_f32_bf16 v6, s70, v162
    v_dot2c_f32_bf16 v7, s70, v163
    v_dot2c_f32_bf16 v9, s70, v165
    v_dot2c_f32_bf16 v10, s70, v166
    v_dot2c_f32_bf16 v11, s70, v167
    v_dot2c_f32_bf16 v4, s71, v168
    v_dot2c_f32_bf16 v8, s71, v172
    v_dot2c_f32_bf16 v5, s71, v169
    v_dot2c_f32_bf16 v6, s71, v170
    v_dot2c_f32_bf16 v7, s71, v171
    v_dot2c_f32_bf16 v9, s71, v173
    v_dot2c_f32_bf16 v10, s71, v174
    v_dot2c_f32_bf16 v11, s71, v175
    v_dot2c_f32_bf16 v4, s72, v176
    v_dot2c_f32_bf16 v8, s72, v180
    v_dot2c_f32_bf16 v5, s72, v177
    v_dot2c_f32_bf16 v6, s72, v178
    v_dot2c_f32_bf16 v7, s72, v179
    v_dot2c_f32_bf16 v9, s72, v181
    v_dot2c_f32_bf16 v10, s72, v182
    v_dot2c_f32_bf16 v11, s72, v183
    v_dot2c_f32_bf16 v4, s73, v184
    v_dot2c_f32_bf16 v8, s73, v188
    v_dot2c_f32_bf16 v5, s73, v185
    v_dot2c_f32_bf16 v6, s73, v186
    v_dot2c_f32_bf16 v7, s73, v187
    v_dot2c_f32_bf16 v9, s73, v189
    v_dot2c_f32_bf16 v10, s73, v190
    v_dot2c_f32_bf16 v11, s73, v191
    v_and_or_b32 v12, v12, -16, 12
    v_and_b32_e64 v4, -16, v4
    v_and_b32 v8, -16, v8
    s_cbranch_scc1 L_slow_116
    buffer_store_dwordx4 v[4:7], v28, s[40:43], s10 offen
    buffer_store_dwordx4 v[8:11], v28, s[40:43], s10 offen offset:16
    v_mov_b32 v13, v5
    buffer_store_dwordx2 v[12:13], v14, s[40:43], s7 offen
L_pub_117:
    s_cmp_ge_u32 s5, 28
    s_cbranch_scc1 L_nof_118
L_wf_119:
    ds_read_b32 v30, v31 offset:3608
    s_waitcnt lgkmcnt(0)
    v_readfirstlane_b32 s10, v30
    s_nop 0
    s_cmp_ge_u32 s10, 2
    s_cbranch_scc0 L_wfr_120
L_nof_118:
    s_add_u32 s10, s7, 0x50000
    s_add_u32 s11, s10, 8192
    s_mov_b32 s65, 0
    s_nop 15
    s_nop 15
    s_nop 15
    s_nop 15
    s_nop 15
    s_nop 15
    s_nop 15
    buffer_load_dwordx4 v[32:35], v21, s[40:43], s7 offen sc1
    buffer_load_dwordx4 v[36:39], v23, s[40:43], s7 offen sc1
    s_nop 15
    s_nop 15
L_gp_121:
    buffer_load_dwordx4 v[40:43], v21, s[40:43], s7 offen sc1
    buffer_load_dwordx4 v[44:47], v23, s[40:43], s7 offen sc1
    s_add_u32 s65, s65, 1
    s_cmp_lt_u32 s65, s3
    s_cbranch_scc0 L_gz_125
    s_waitcnt vmcnt(2)
    v_bitop3_b32 v12, v32, v36, 8 bitop3:0xa8
    v_cmp_ne_u32 vcc, 0, v12
    v_add_f32 v4, v32, v36
    v_add_f32 v5, v33, v37
    v_add_f32 v6, v34, v38
    v_add_f32_e64 v7, v35, v39
    v_permlane32_swap_b32 v4, v5
    s_cbranch_vccz L_gd_122
    buffer_load_dwordx4 v[32:35], v21, s[40:43], s7 offen sc1
    buffer_load_dwordx4 v[36:39], v23, s[40:43], s7 offen sc1
    s_waitcnt vmcnt(2)
    v_bitop3_b32 v12, v40, v44, 8 bitop3:0xa8
    v_cmp_ne_u32 vcc, 0, v12
    v_add_f32 v4, v40, v44
    v_add_f32 v5, v41, v45
    v_add_f32 v6, v42, v46
    v_add_f32 v7, v43, v47
    v_permlane32_swap_b32 v4, v5
    s_cbranch_vccnz L_gp_121
L_gz_125:
L_gd_122:
    v_permlane32_swap_b32 v6, v7
    v_add_f32 v4, v4, v5
    v_add_f32 v6, v6, v7
    s_nop 1
    v_permlane16_swap_b32 v4, v6
    v_add_f32 v4, v4, v6
    s_nop 1
    v_add_f32_dpp v4, v4, v4 row_ror:4 row_mask:0xf bank_mask:0xf
    s_nop 1
    v_add_f32_dpp v4, v4, v4 row_ror:8 row_mask:0xf bank_mask:0xf
    v_and_or_b32 v4, v4, -16, 12
    buffer_store_dword v4, v24, s[40:43], s10 offen sc1
    buffer_store_dword v4, v24, s[40:43], s11 offen sc1
    s_cmp_lg_u32 s6, 0
    s_cbranch_scc1 L_fin_126
    s_mov_b32 s65, 0
    s_nop 15
    s_nop 15
    s_nop 15
    s_nop 15
    s_nop 15
    s_nop 15
    buffer_load_dwordx2 v[56:57], v25, s[40:43], s10 offen sc1
    s_nop 15
    s_nop 15
    s_nop 15
    buffer_load_dwordx2 v[58:59], v25, s[40:43], s10 offen sc1
    s_nop 15
    s_nop 15
    s_nop 15
L_gp_127:
    buffer_load_dwordx2 v[60:61], v25, s[40:43], s10 offen sc1
    s_add_u32 s65, s65, 1
    s_cmp_lt_u32 s65, s3
    s_cbranch_scc0 L_gz_132
    s_waitcnt vmcnt(2)
    v_bitop3_b32 v6, v56, v57, 2 bitop3:0xa8
    v_cmp_ne_u32 vcc, 0, v6
    v_permlane32_swap_b32 v56, v57
    v_add_f32 v4, v56, v57
    v_mov_b32 v5, v4
    s_nop 0
    s_cbranch_vccz L_gd_128
    buffer_load_dwordx2 v[56:57], v25, s[40:43], s10 offen sc1
    s_waitcnt vmcnt(2)
    v_bitop3_b32 v6, v58, v59, 2 bitop3:0xa8
    v_cmp_ne_u32 vcc, 0, v6
    v_permlane32_swap_b32 v58, v59
    v_add_f32 v4, v58, v59
    v_mov_b32 v5, v4
    s_nop 0
    s_cbranch_vccz L_gd_128
    buffer_load_dwordx2 v[58:59], v25, s[40:43], s10 offen sc1
    s_waitcnt vmcnt(2)
    v_bitop3_b32 v6, v60, v61, 2 bitop3:0xa8
    v_cmp_ne_u32 vcc, 0, v6
    v_permlane32_swap_b32 v60, v61
    v_add_f32 v4, v60, v61
    v_mov_b32 v5, v4
    s_nop 0
    s_cbranch_vccnz L_gp_127
L_gz_132:
L_gd_128:
    v_permlane16_swap_b32 v4, v5
    v_add_f32 v4, v4, v5
    s_nop 1
    v_add_f32_dpp v4, v4, v4 row_ror:8 row_mask:0xf bank_mask:0xf
    v_cvt_pk_bf16_f32 v4, 0, v4
    v_add_f32_e64 v4, v20, v4
    v_cvt_pk_bf16_f32 v4, v4, v4
    v_mov_b32 v5, v4
    v_and_b32 v20, s76, v4
    s_nop 0
    v_permlane32_swap_b32 v4, v5
    v_bfi_b32 v4, s76, v5, v4
    buffer_store_dword v4, v27, s[60:63], 0 offen
L_fin_126:
    s_endpgm
L_slow_55:
    s_nop 4
    buffer_store_dwordx4 v[16:19], v29, s[40:43], s7 offen sc1
    buffer_store_dwordx4 v[16:19], v29, s[40:43], s7 offen offset:1024 sc1
    s_branch L_pub_56
L_slow_57:
    s_nop 4
    buffer_store_dwordx4 v[16:19], v29, s[40:43], s11 offen sc1
    buffer_store_dwordx4 v[16:19], v29, s[40:43], s11 offen offset:1024 sc1
    s_branch L_pub_58
L_wad_61:
    s_nop 4
    s_sleep 1
    s_branch L_wa_60
    s_nop 0
L_slow_62:
    s_nop 4
    buffer_store_dwordx4 v[4:7], v28, s[40:43], s10 offen sc1
    buffer_store_dwordx4 v[8:11], v28, s[40:43], s10 offen offset:16 sc1
    s_branch L_pub_63
    s_nop 0
L_wfr_65:
    s_nop 4
    s_sleep 1
    s_branch L_wf_64
L_wfr_73:
    s_nop 4
    s_sleep 1
    s_branch L_wf_72
L_wfr_76:
    s_nop 4
    s_sleep 1
    s_branch L_wf_75
L_slow_83:
    s_nop 4
    buffer_store_dwordx4 v[4:7], v28, s[40:43], s10 offen sc1
    buffer_store_dwordx4 v[8:11], v28, s[40:43], s10 offen offset:16 sc1
    v_mov_b32_e64 v13, v5
    buffer_store_dwordx2 v[12:13], v14, s[40:43], s7 offen sc1
    s_branch L_pub_84
    s_nop 0
L_wfr_87:
    s_nop 4
    s_sleep 1
    s_branch L_wf_86
L_slow_100:
    s_nop 4
    buffer_store_dword v4, v26, s[40:43], s7 offen sc1
    s_branch L_pub_101
L_wfr_103:
    s_nop 4
    s_sleep 1
    s_branch L_wf_102
    s_nop 0
L_slow_116:
    s_nop 4
    buffer_store_dwordx4 v[4:7], v28, s[40:43], s10 offen sc1
    buffer_store_dwordx4 v[8:11], v28, s[40:43], s10 offen offset:16 sc1
    v_mov_b32_e64 v13, v5
    buffer_store_dwordx2 v[12:13], v14, s[40:43], s7 offen sc1
    s_branch L_pub_117
L_wfr_120:
    s_nop 4
    s_sleep 1
    s_branch L_wf_119
    s_nop 0
L_roleD:
    s_setprio 3
    s_cmp_lg_u32 s7, 0
    s_cbranch_scc1 L_d_slowpass
    v_mov_b32 v16, -1
    v_mov_b32 v17, -1
    v_mov_b32 v18, -1
    v_mov_b32 v19, -1
    s_and_b32 s12, s5, 3
    s_lshl_b32 s12, s12, 11
    s_lshr_b32 s13, s5, 2
    s_lshl_b32 s13, s13, 7
    s_add_u32 s12, s12, s13
    s_lshl_b32 s13, s6, 13
    s_add_u32 s13, s13, 0x20000
    v_cmp_gt_u32_e64 vcc, 32, v0
    v_mov_b32 v26, s12
    s_nop 0
    v_cndmask_b32 v26, 0, v26, vcc
    v_and_b32 v25, 7, v0
    v_lshl_add_u32 v25, v25, 4, v26
    v_bfe_u32 v26, v0, 3, 1
    v_lshl_add_u32 v25, v26, 10, v25
    v_add_u32 v25, s13, v25
    s_lshl_b32 s12, s5, 5
    s_lshl_b32 s13, s6, 10
    v_mov_b32 v26, s12
    v_cndmask_b32 v26, 0, v26, vcc
    v_and_b32 v27, 1, v0
    v_lshl_add_u32 v26, v27, 4, v26
    v_add_u32 v26, s13, v26
    v_and_b32 v27, 16, v0
    v_cmp_eq_u32 vcc, 0, v27
    s_nop 1
    v_cndmask_b32 v25, v26, v25, vcc
    v_cmp_gt_u32 vcc, 32, v0
    v_mov_b32 v24, s5
    s_nop 0
    v_cndmask_b32 v24, 0, v24, vcc
    v_and_b32 v26, 15, v0
    v_lshl_add_u32 v24, v26, 6, v24
    s_lshl_b32 s12, s6, 10
    s_add_u32 s14, s12, 0x10000
    s_waitcnt lgkmcnt(0)
    s_mov_b32 s40, s38
    s_and_b32 s41, s39, 0xffff
    s_mov_b32 s42, 0x10000000
    s_mov_b32 s43, 0x20000
    s_mov_b32 exec_lo, 0x3ffff
    s_cmp_eq_u32 s5, 1
    s_cselect_b32 exec_hi, 0x3ffff, 0
    buffer_store_dwordx4 v[16:19], v25, s[40:43], 0 offen
    s_and_b32 exec_lo, exec_lo, 0xffff
    s_and_b32 exec_hi, exec_hi, 0xffff
    s_barrier
    s_barrier
    buffer_store_byte v16, v24, s[40:43], s14 offen
    s_mov_b64 exec, -1
    s_lshl_b32 s12, s6, 11
    s_and_b32 s13, s5, 15
    s_lshl_b32 s13, s13, 4
    s_add_u32 s12, s12, s13
    s_lshr_b32 s13, s5, 4
    s_lshl_b32 s13, s13, 3
    s_add_u32 s12, s12, s13
    s_add_u32 s12, s12, 0x8000
    s_add_u32 s12, s12, -1024
    v_lshl_add_u32 v26, v0, 8, s12
    s_lshl_b32 s12, s9, 5
    s_add_u32 s12, s12, 0x4000
    v_lshl_add_u32 v27, v0, 3, s12
    v_cmp_gt_u32_e64 vcc, 4, v0
    s_nop 1
    v_cndmask_b32 v26, v26, v27, vcc
    s_mov_b64 exec, 0x1ff
    buffer_store_dwordx2 v[16:17], v26, s[40:43], s7 offen sc1
    s_mov_b64 exec, -1
    s_mov_b32 s79, 0
    s_mov_b32 s56, s36
    s_and_b32 s57, s37, 0xffff
    s_mov_b32 s58, 0x100
    s_mov_b32 s59, 0x20000
    s_waitcnt lgkmcnt(0)
    s_barrier
    v_mov_b32 v29, s9
    s_lshl_b32 s12, s6, 5
    v_lshl_add_u32 v5, v0, 2, s12
    v_lshlrev_b32 v6, 5, v0
    v_add_u32 v10, s12, v0
    v_lshlrev_b32 v10, 5, v10
    v_lshlrev_b32 v11, 5, v29
    s_mov_b32 s13, 0x01010101
    v_mov_b32 v8, -1
    v_mov_b32 v9, s13
    s_mov_b32 s14, 0xffffff00
    v_writelane_b32 v8, s14, 0
    s_mov_b32 s14, 0x01010100
    v_writelane_b32 v9, s14, 0
    v_mov_b32 v28, 1
    s_mov_b32 s65, 0
    s_cmp_eq_u32 s5, 0
    s_cbranch_scc1 L_d_leader
    s_mov_b64 exec, 1
    s_waitcnt vmcnt(1)
    buffer_store_byte v28, v29, s[56:59], 0 offen
L_d_leader:
    s_mov_b64 exec, 0xff
    buffer_load_dword v40, v5, s[56:59], 0 offen nt
    s_sleep 3
    buffer_load_dword v41, v5, s[56:59], 0 offen nt
    s_sleep 3
    buffer_load_dword v42, v5, s[56:59], 0 offen nt
    s_sleep 3
    buffer_load_dword v43, v5, s[56:59], 0 offen nt
    s_sleep 3
    buffer_load_dword v44, v5, s[56:59], 0 offen nt
    s_sleep 3
    buffer_load_dword v45, v5, s[56:59], 0 offen nt
    s_waitcnt vmcnt(6)
    v_mov_b32 v30, 1
    ds_write_b32 v31, v30 offset:3620
L_d_lpoll:
    s_waitcnt vmcnt(5)
    v_and_b32 v7, v40, v8
    v_cmp_ne_u32 vcc, v7, v9
    s_cbranch_vccz L_d_window
    ds_read_b32 v30, v31 offset:3588
    s_waitcnt lgkmcnt(0)
    v_readfirstlane_b32 s14, v30
    s_nop 0
    s_cmp_lg_u32 s14, 0
    s_cbranch_scc1 L_d_window
    buffer_load_dword v40, v5, s[56:59], 0 offen nt
    v_readfirstlane_b32 s14, v7
    s_bitcmp1_b32 s14, 8
    s_cbranch_scc0 L_now1_133
    v_mov_b32 v30, 1
    ds_write_b32 v31, v30 offset:3616
L_now1_133:
    s_waitcnt vmcnt(5)
    v_and_b32 v7, v41, v8
    v_cmp_ne_u32 vcc, v7, v9
    s_cbranch_vccz L_d_window
    ds_read_b32 v30, v31 offset:3588
    s_waitcnt lgkmcnt(0)
    v_readfirstlane_b32 s14, v30
    s_nop 0
    s_cmp_lg_u32 s14, 0
    s_cbranch_scc1 L_d_window
    buffer_load_dword v41, v5, s[56:59], 0 offen nt
    v_readfirstlane_b32 s14, v7
    s_bitcmp1_b32 s14, 8
    s_cbranch_scc0 L_now1_134
    v_mov_b32 v30, 1
    ds_write_b32 v31, v30 offset:3616
L_now1_134:
    s_waitcnt vmcnt(5)
    v_and_b32 v7, v42, v8
    v_cmp_ne_u32 vcc, v7, v9
    s_cbranch_vccz L_d_window
    ds_read_b32 v30, v31 offset:3588
    s_waitcnt lgkmcnt(0)
    v_readfirstlane_b32 s14, v30
    s_nop 0
    s_cmp_lg_u32 s14, 0
    s_cbranch_scc1 L_d_window
    buffer_load_dword v42, v5, s[56:59], 0 offen nt
    v_readfirstlane_b32 s14, v7
    s_bitcmp1_b32 s14, 8
    s_cbranch_scc0 L_now1_135
    v_mov_b32 v30, 1
    ds_write_b32 v31, v30 offset:3616
L_now1_135:
    s_waitcnt vmcnt(5)
    v_and_b32 v7, v43, v8
    v_cmp_ne_u32 vcc, v7, v9
    s_cbranch_vccz L_d_window
    ds_read_b32 v30, v31 offset:3588
    s_waitcnt lgkmcnt(0)
    v_readfirstlane_b32 s14, v30
    s_nop 0
    s_cmp_lg_u32 s14, 0
    s_cbranch_scc1 L_d_window
    buffer_load_dword v43, v5, s[56:59], 0 offen nt
    v_readfirstlane_b32 s14, v7
    s_bitcmp1_b32 s14, 8
    s_cbranch_scc0 L_now1_136
    v_mov_b32 v30, 1
    ds_write_b32 v31, v30 offset:3616
L_now1_136:
    s_waitcnt vmcnt(5)
    v_and_b32 v7, v44, v8
    v_cmp_ne_u32 vcc, v7, v9
    s_cbranch_vccz L_d_window
    ds_read_b32 v30, v31 offset:3588
    s_waitcnt lgkmcnt(0)
    v_readfirstlane_b32 s14, v30
    s_nop 0
    s_cmp_lg_u32 s14, 0
    s_cbranch_scc1 L_d_window
    buffer_load_dword v44, v5, s[56:59], 0 offen nt
    v_readfirstlane_b32 s14, v7
    s_bitcmp1_b32 s14, 8
    s_cbranch_scc0 L_now1_137
    v_mov_b32 v30, 1
    ds_write_b32 v31, v30 offset:3616
L_now1_137:
    s_waitcnt vmcnt(5)
    v_and_b32 v7, v45, v8
    v_cmp_ne_u32 vcc, v7, v9
    s_cbranch_vccz L_d_window
    ds_read_b32 v30, v31 offset:3588
    s_waitcnt lgkmcnt(0)
    v_readfirstlane_b32 s14, v30
    s_nop 0
    s_cmp_lg_u32 s14, 0
    s_cbranch_scc1 L_d_window
    buffer_load_dword v45, v5, s[56:59], 0 offen nt
    v_readfirstlane_b32 s14, v7
    s_bitcmp1_b32 s14, 8
    s_cbranch_scc0 L_now1_138
    v_mov_b32 v30, 1
    ds_write_b32 v31, v30 offset:3616
L_now1_138:
    s_add_u32 s65, s65, 1
    s_cmp_lt_u32 s65, 64
    s_cbranch_scc1 L_d_lpoll
L_d_join1:
    s_mov_b64 exec, -1
    s_mov_b32 s72, s6
    s_mov_b32 s73, s9
    s_and_b32 s6, s2, 7
    s_mov_b32 s7, 0x1000000
    s_lshl_b32 s9, s6, 5
    s_add_u32 s9, s9, s5
    v_mov_b32 v16, -1
    v_mov_b32 v17, -1
    v_mov_b32 v18, -1
    v_mov_b32 v19, -1
    s_and_b32 s12, s5, 3
    s_lshl_b32 s12, s12, 11
    s_lshr_b32 s13, s5, 2
    s_lshl_b32 s13, s13, 7
    s_add_u32 s12, s12, s13
    s_lshl_b32 s13, s6, 13
    s_add_u32 s13, s13, 0x20000
    v_cmp_gt_u32_e64 vcc, 32, v0
    v_mov_b32 v26, s12
    s_nop 0
    v_cndmask_b32 v26, 0, v26, vcc
    v_and_b32 v25, 7, v0
    v_lshl_add_u32 v25, v25, 4, v26
    v_bfe_u32 v26, v0, 3, 1
    v_lshl_add_u32 v25, v26, 10, v25
    v_add_u32 v25, s13, v25
    s_lshl_b32 s12, s5, 5
    s_lshl_b32 s13, s6, 10
    v_mov_b32 v26, s12
    v_cndmask_b32 v26, 0, v26, vcc
    v_and_b32 v27, 1, v0
    v_lshl_add_u32 v26, v27, 4, v26
    v_add_u32 v26, s13, v26
    v_and_b32 v27, 16, v0
    v_cmp_eq_u32_e64 vcc, 0, v27
    s_nop 1
    v_cndmask_b32 v25, v26, v25, vcc
    s_mov_b64 exec, 0xffff
    buffer_store_dwordx4 v[16:19], v25, s[40:43], s7 offen sc1
    s_mov_b64 exec, -1
    s_lshl_b32 s12, s6, 11
    s_and_b32 s13, s5, 15
    s_lshl_b32 s13, s13, 4
    s_add_u32 s12, s12, s13
    s_lshr_b32 s13, s5, 4
    s_lshl_b32 s13, s13, 3
    s_add_u32 s12, s12, s13
    s_add_u32 s12, s12, 0x8000
    s_add_u32 s12, s12, -1024
    v_lshl_add_u32 v26, v0, 8, s12
    s_lshl_b32 s12, s9, 5
    s_add_u32 s12, s12, 0x4000
    v_lshl_add_u32 v27, v0, 3, s12
    v_cmp_gt_u32 vcc, 4, v0
    s_nop 1
    v_cndmask_b32 v26, v26, v27, vcc
    s_mov_b64 exec, 0x1ff
    buffer_store_dwordx2 v[16:17], v26, s[40:43], s7 offen sc1
    s_mov_b64 exec, -1
    s_and_b32 s12, s5, 7
    s_lshl_b32 s12, s12, 10
    s_lshr_b32 s13, s5, 3
    s_lshl_b32 s13, s13, 14
    s_add_u32 s12, s12, s13
    s_lshl_b32 s13, s6, 7
    s_add_u32 s12, s12, s13
    s_add_u32 s12, s12, 0x40000
    v_and_b32_e64 v27, 3, v0
    v_lshl_add_u32 v27, v27, 4, s12
    v_bfe_u32 v28, v0, 2, 1
    v_lshl_add_u32 v27, v28, 13, v27
    v_bfe_u32 v28, v0, 3, 1
    v_lshl_add_u32 v27, v28, 16, v27
    s_mov_b64 exec, 0xffff
    buffer_store_dwordx4 v[16:19], v27, s[40:43], s7 offen sc1
    s_mov_b64 exec, -1
    s_lshl_b32 s12, s6, 5
    v_mov_b32_e64 v28, 2
    v_mov_b32 v29, s12
    s_mov_b32 s6, s72
    s_mov_b32 s9, s73
    s_mov_b32 s7, 0
    s_waitcnt vmcnt(0)
    s_mov_b64 exec, 1
    buffer_atomic_add v28, v29, s[56:59], 0 offen
    s_mov_b64 exec, 0xff
    s_mov_b32 s65, 0
L_spoll_139:
    buffer_load_dword v7, v6, s[56:59], 0 offen sc1
    s_waitcnt vmcnt(0)
    v_and_b32_e64 v8, 1, v7
    v_cmp_ne_u32 vcc, 1, v8
    s_cbranch_vccz L_d_fast1
    v_bfe_u32 v8, v7, 1, 7
    v_cmp_ne_u32 vcc, 32, v8
    s_cbranch_vccz L_d_slow1
    s_sleep 2
    s_add_u32 s65, s65, 1
    s_cmp_lt_u32 s65, 32768
    s_cbranch_scc1 L_spoll_139
    s_branch L_d_slow1
L_d_slow1:
    s_mov_b64 exec, -1
    v_mov_b32 v30, 1
    ds_write_b32 v31, v30 offset:3584
    v_mov_b32 v30, 2
    ds_write_b32 v31, v30 offset:3616
    v_mov_b32 v30, 2
    ds_write_b32 v31, v30 offset:3588
    s_waitcnt lgkmcnt(0)
    s_barrier
    s_branch L_fallback
    s_nop 0
L_d_slowpass:
    s_waitcnt lgkmcnt(0)
    s_mov_b32 s40, s38
    s_and_b32 s41, s39, 0xffff
    s_mov_b32 s42, 0x10000000
    s_mov_b32 s43, 0x20000
    s_mov_b32 s79, 0
    s_mov_b32 s56, s36
    s_and_b32 s57, s37, 0xffff
    s_mov_b32 s58, 0x100
    s_mov_b32 s59, 0x20000
    s_waitcnt lgkmcnt(0)
    s_barrier
    s_barrier
    s_barrier
L_d_fast1:
    s_mov_b32 s79, 1
    v_mov_b32 v30, 1
    ds_write_b32 v31, v30 offset:3592
    v_mov_b32_e64 v30, 1
    ds_write_b32 v31, v30 offset:3620
    v_mov_b32 v30, 1
    ds_write_b32 v31, v30 offset:3616
    v_mov_b32 v30, 1
    ds_write_b32 v31, v30 offset:3588
    s_branch L_d_go
L_d_window:
    v_mov_b32 v30, 1
    ds_write_b32 v31, v30 offset:3616
    v_mov_b32_e64 v30, 1
    ds_write_b32 v31, v30 offset:3588
L_d_go:
    s_mov_b64 exec, -1
    s_mov_b32 s52, s32
    s_and_b32 s53, s33, 0xffff
    s_mov_b32 s54, 0x1c0000
    s_mov_b32 s55, 0x20000
    v_lshlrev_b32 v2, 4, v0
    s_mul_i32 s70, s6, 28
    s_add_u32 s70, s70, s5
    s_lshl_b32 s70, s70, 13
    s_add_u32 s71, s70, 4096
    s_mov_b32 s76, 0xffff0000
    s_mov_b32 s77, 0x05040100
    s_mov_b32 s78, 0x07060302
    s_mov_b32 s75, 0xbfb8aa3b
    s_lshl_b32 s10, s9, 11
    s_add_u32 s10, s10, 0x180000
    s_lshl_b32 s11, s5, 7
    v_lshl_add_u32 v1, v0, 5, s11
    v_and_b32 v1, 0x7ff, v1
    v_add_u32 v1, s10, v1
    s_lshl_b32 s14, s6, 16
    s_lshl_b32 s13, s5, 6
    s_add_u32 s14, s14, 0x100000
    v_lshrrev_b32 v3, 2, v0
    v_lshl_add_u32 v4, v3, 7, s13
    v_and_b32 v4, 0x7ff, v4
    v_lshl_add_u32 v3, v3, 11, v4
    v_and_b32 v12, 3, v0
    v_lshl_add_u32 v3, v12, 4, v3
    v_add_u32 v3, s14, v3
    v_add_u32 v4, 0x8000, v3
    s_lshl_b32 s10, s6, 11
    s_add_u32 s10, s10, 0x8400
    v_lshrrev_b32 v13, 2, v0
    v_lshl_add_u32 v13, v13, 4, s10
    s_cmp_eq_u32 s5, 0
    s_cselect_b32 s12, 1, -1
    s_cselect_b32 s13, 1, 2
    s_cselect_b32 s72, 0xff, 1
    s_barrier
    s_cmp_lg_u32 s5, 0
    s_cbranch_scc1 L_noann_140
    s_cmp_lg_u32 s79, 0
    s_cbranch_scc1 L_noann_140
    s_mov_b64 exec, 1
    buffer_atomic_or v28, v29, s[56:59], 0 offen
L_noann_140:
    s_mov_b64 exec, -1
    s_barrier
    s_cmp_lg_u32 s79, 0
    s_cbranch_scc1 L_d_ver0
    s_mov_b32 exec_lo, s72
    s_mov_b32 exec_hi, 0
    s_mov_b32 s65, 0
L_d_gpoll:
    s_cmp_lg_u32 s5, 0
    s_cbranch_scc1 L_smem_141
    s_mov_b64 exec, 0xff
    buffer_load_dword v7, v6, s[56:59], 0 offen sc1
    s_branch L_sdone_142
L_smem_141:
    s_mov_b64 exec, 1
    buffer_load_dword v7, v11, s[40:43], 0 offen offset:0 sc1
L_sdone_142:
    s_waitcnt vmcnt(0)
L_d_gtest:
    v_and_b32 v7, s12, v7
    v_cmp_ne_u32 vcc, s13, v7
    s_cbranch_vccz L_d_ver
    s_add_u32 s65, s65, 1
    s_cmp_lt_u32 s65, 128
    s_cbranch_scc1 L_d_gpoll
    s_mov_b64 exec, -1
    s_mov_b32 s72, s6
    s_mov_b32 s73, s9
    s_and_b32 s6, s2, 7
    s_mov_b32 s7, 0x1000000
    s_lshl_b32 s9, s6, 5
    s_add_u32 s9, s9, s5
    v_mov_b32 v16, -1
    v_mov_b32 v17, -1
    v_mov_b32 v18, -1
    v_mov_b32 v19, -1
    s_and_b32 s12, s5, 3
    s_lshl_b32 s12, s12, 11
    s_lshr_b32 s13, s5, 2
    s_lshl_b32 s13, s13, 7
    s_add_u32 s12, s12, s13
    s_lshl_b32 s13, s6, 13
    s_add_u32 s13, s13, 0x20000
    v_cmp_gt_u32_e64 vcc, 32, v0
    v_mov_b32 v26, s12
    s_nop 0
    v_cndmask_b32 v26, 0, v26, vcc
    v_and_b32 v25, 7, v0
    v_lshl_add_u32 v25, v25, 4, v26
    v_bfe_u32 v26, v0, 3, 1
    v_lshl_add_u32 v25, v26, 10, v25
    v_add_u32 v25, s13, v25
    s_lshl_b32 s12, s5, 5
    s_lshl_b32 s13, s6, 10
    v_mov_b32 v26, s12
    v_cndmask_b32 v26, 0, v26, vcc
    v_and_b32 v27, 1, v0
    v_lshl_add_u32 v26, v27, 4, v26
    v_add_u32 v26, s13, v26
    v_and_b32 v27, 16, v0
    v_cmp_eq_u32_e64 vcc, 0, v27
    s_nop 1
    v_cndmask_b32 v25, v26, v25, vcc
    s_mov_b64 exec, 0xffff
    buffer_store_dwordx4 v[16:19], v25, s[40:43], s7 offen sc1
    s_mov_b64 exec, -1
    s_lshl_b32 s12, s6, 11
    s_and_b32 s13, s5, 15
    s_lshl_b32 s13, s13, 4
    s_add_u32 s12, s12, s13
    s_lshr_b32 s13, s5, 4
    s_lshl_b32 s13, s13, 3
    s_add_u32 s12, s12, s13
    s_add_u32 s12, s12, 0x8000
    s_add_u32 s12, s12, -1024
    v_lshl_add_u32 v26, v0, 8, s12
    s_lshl_b32 s12, s9, 5
    s_add_u32 s12, s12, 0x4000
    v_lshl_add_u32 v27, v0, 3, s12
    v_cmp_gt_u32 vcc, 4, v0
    s_nop 1
    v_cndmask_b32 v26, v26, v27, vcc
    s_mov_b64 exec, 0x1ff
    buffer_store_dwordx2 v[16:17], v26, s[40:43], s7 offen sc1
    s_mov_b64 exec, -1
    s_and_b32 s12, s5, 7
    s_lshl_b32 s12, s12, 10
    s_lshr_b32 s13, s5, 3
    s_lshl_b32 s13, s13, 14
    s_add_u32 s12, s12, s13
    s_lshl_b32 s13, s6, 7
    s_add_u32 s12, s12, s13
    s_add_u32 s12, s12, 0x40000
    v_and_b32_e64 v27, 3, v0
    v_lshl_add_u32 v27, v27, 4, s12
    v_bfe_u32 v28, v0, 2, 1
    v_lshl_add_u32 v27, v28, 13, v27
    v_bfe_u32 v28, v0, 3, 1
    v_lshl_add_u32 v27, v28, 16, v27
    s_mov_b64 exec, 0xffff
    buffer_store_dwordx4 v[16:19], v27, s[40:43], s7 offen sc1
    s_mov_b64 exec, -1
    s_lshl_b32 s12, s6, 5
    v_mov_b32_e64 v28, 2
    v_mov_b32 v29, s12
    s_mov_b32 s6, s72
    s_mov_b32 s9, s73
    s_mov_b32 s7, 0
    s_waitcnt vmcnt(0)
    s_mov_b64 exec, 1
    buffer_atomic_add v28, v29, s[56:59], 0 offen
    s_mov_b64 exec, 0xff
    s_mov_b32 s65, 0
L_spoll_143:
    buffer_load_dword v7, v6, s[56:59], 0 offen sc1
    s_waitcnt vmcnt(0)
    v_and_b32_e64 v8, 1, v7
    v_cmp_ne_u32 vcc, 1, v8
    s_cbranch_vccz L_d_ver
    v_bfe_u32 v8, v7, 1, 7
    v_cmp_ne_u32 vcc, 32, v8
    s_cbranch_vccz L_d_slow2
    s_sleep 2
    s_add_u32 s65, s65, 1
    s_cmp_lt_u32 s65, 32768
    s_cbranch_scc1 L_spoll_143
    s_branch L_d_slow2
L_d_slow2:
    s_mov_b64 exec, -1
    v_mov_b32 v30, 1
    ds_write_b32 v31, v30 offset:3584
    v_mov_b32_e64 v30, 2
    ds_write_b32 v31, v30 offset:3592
    s_waitcnt lgkmcnt(0)
    s_barrier
    s_barrier
    s_branch L_fallback
L_d_ver:
    s_cmp_lg_u32 s5, 0
    s_cbranch_scc1 L_d_ver0
    s_mov_b64 exec, 0xffffffff
    v_mov_b32_e64 v28, 2
    buffer_store_dword v28, v10, s[40:43], 0 offen offset:0
L_d_ver0:
    s_mov_b64 exec, -1
    v_mov_b32 v30, 1
    ds_write_b32 v31, v30 offset:3592
    s_waitcnt lgkmcnt(0)
    s_cmp_ge_u32 s5, 28
    s_cbranch_scc1 L_noffn_144
L_wf_145:
    ds_read_b32 v30, v31 offset:3604
    s_waitcnt lgkmcnt(0)
    v_readfirstlane_b32 s10, v30
    s_nop 0
    s_cmp_ge_u32 s10, 1
    s_cbranch_scc0 L_wfr_146
    s_cmp_ge_u32 s5, 28
    s_cbranch_scc1 L_nodn_147
    buffer_load_dwordx4 v[64:67], v2, s[52:55], s70 offen offset:0 nt
    buffer_load_dwordx4 v[68:71], v2, s[52:55], s70 offen offset:1024 nt
    buffer_load_dwordx4 v[72:75], v2, s[52:55], s70 offen offset:2048 nt
    buffer_load_dwordx4 v[76:79], v2, s[52:55], s70 offen offset:3072 nt
    buffer_load_dwordx4 v[80:83], v2, s[52:55], s71 offen offset:0 nt
    buffer_load_dwordx4 v[84:87], v2, s[52:55], s71 offen offset:1024 nt
    buffer_load_dwordx4 v[88:91], v2, s[52:55], s71 offen offset:2048 nt
    buffer_load_dwordx4 v[92:95], v2, s[52:55], s71 offen offset:3072 nt
L_nodn_147:
L_wf_148:
    ds_read_b32 v30, v31 offset:3604
    s_waitcnt lgkmcnt(0)
    v_readfirstlane_b32 s10, v30
    s_nop 0
    s_cmp_ge_u32 s10, 1
    s_cbranch_scc0 L_wfr_149
L_wf_150:
    ds_read_b32 v30, v31 offset:3596
    s_waitcnt lgkmcnt(0)
    v_readfirstlane_b32 s10, v30
    s_nop 0
    s_cmp_ge_u32 s10, 1
    s_cbranch_scc0 L_wfr_151
    s_add_u32 s10, s7, 0x100000
    s_mov_b32 s65, 0
L_gp_152:
    buffer_load_dwordx4 v[96:99], v3, s[40:43], s10 offen sc1
    buffer_load_dwordx4 v[100:103], v4, s[40:43], s10 offen sc1
    s_add_u32 s65, s65, 1
    s_cmp_lt_u32 s65, s3
    s_waitcnt vmcnt(0)
    v_bitop3_b32 v18, v96, v100, 1 bitop3:0xa8
    v_cmp_ne_u32 vcc, 0, v18
    s_cbranch_scc0 L_gd_153
    s_cbranch_vccnz L_gp_152
L_gd_153:
    v_add_f32 v8, v96, v100
    v_add_f32 v9, v97, v101
    v_add_f32 v10, v98, v102
    v_add_f32 v11, v99, v103
    v_permlane32_swap_b32 v8, v9
    s_nop 0
    v_permlane32_swap_b32 v10, v11
    v_add_f32 v8, v8, v9
    v_add_f32 v10, v10, v11
    s_nop 1
    v_permlane16_swap_b32 v8, v10
    v_add_f32_e64 v8, v8, v10
    s_nop 1
    v_add_f32_dpp v8, v8, v8 row_ror:4 row_mask:0xf bank_mask:0xf
    s_nop 1
    v_add_f32_dpp v8, v8, v8 row_ror:8 row_mask:0xf bank_mask:0xf
    v_mov_b32 v24, v8
    s_waitcnt vmcnt(0)
    v_perm_b32 v32, v68, v64, s77
    v_perm_b32 v33, v68, v64, s78
    v_perm_b32 v34, v69, v65, s77
    v_perm_b32 v35, v69, v65, s78
    v_perm_b32 v36, v70, v66, s77
    v_perm_b32 v37, v70, v66, s78
    v_perm_b32 v38, v71, v67, s77
    v_perm_b32 v39, v71, v67, s78
    v_perm_b32 v40, v76, v72, s77
    v_perm_b32 v41, v76, v72, s78
    v_perm_b32 v42, v77, v73, s77
    v_perm_b32 v43, v77, v73, s78
    v_perm_b32 v44, v78, v74, s77
    v_perm_b32 v45, v78, v74, s78
    v_perm_b32 v46, v79, v75, s77
    v_perm_b32 v47, v79, v75, s78
    v_perm_b32 v48, v84, v80, s77
    v_perm_b32 v49, v84, v80, s78
    v_perm_b32 v50, v85, v81, s77
    v_perm_b32 v51, v85, v81, s78
    v_perm_b32 v52, v86, v82, s77
    v_perm_b32 v53, v86, v82, s78
    v_perm_b32 v54, v87, v83, s77
    v_perm_b32 v55, v87, v83, s78
    v_perm_b32 v56, v92, v88, s77
    v_perm_b32 v57, v92, v88, s78
    v_perm_b32 v58, v93, v89, s77
    v_perm_b32 v59, v93, v89, s78
    v_perm_b32 v60, v94, v90, s77
    v_perm_b32 v61, v94, v90, s78
    v_perm_b32 v62, v95, v91, s77
    v_perm_b32 v63, v95, v91, s78
L_wf_155:
    ds_read_b32 v30, v31 offset:3604
    s_waitcnt lgkmcnt(0)
    v_readfirstlane_b32 s10, v30
    s_nop 0
    s_cmp_ge_u32 s10, 2
    s_cbranch_scc0 L_wfr_156
    s_mov_b32 s65, 0
    s_nop 0
    s_nop 15
    s_nop 15
    s_nop 15
    s_nop 15
    s_nop 15
    s_nop 15
    s_nop 15
    buffer_load_dwordx4 v[96:99], v3, s[40:43], s7 offen sc1
    buffer_load_dwordx4 v[100:103], v4, s[40:43], s7 offen sc1
    buffer_load_dwordx4 v[104:107], v13, s[40:43], s7 offen sc1
    s_nop 15
    s_nop 15
L_gp_157:
    buffer_load_dwordx4 v[108:111], v3, s[40:43], s7 offen sc1
    buffer_load_dwordx4 v[112:115], v4, s[40:43], s7 offen sc1
    buffer_load_dwordx4 v[116:119], v13, s[40:43], s7 offen sc1
    s_add_u32 s65, s65, 1
    s_cmp_lt_u32 s65, s3
    s_cbranch_scc0 L_gz_161
    s_waitcnt vmcnt(3)
    v_or_b32_e64 v19, v104, v106
    v_lshl_or_b32 v19, v19, 1, v100
    v_bitop3_b32 v18, v96, v19, 2 bitop3:0xa8
    v_cmp_ne_u32 vcc, 0, v18
    v_add_f32 v16, v105, v107
    v_add_f32 v17, v104, v106
    v_add_f32 v8, v96, v100
    v_add_f32 v9, v97, v101
    v_add_f32 v10, v98, v102
    v_add_f32 v11, v99, v103
    s_cbranch_vccz L_gd_158
    buffer_load_dwordx4 v[96:99], v3, s[40:43], s7 offen sc1
    buffer_load_dwordx4 v[100:103], v4, s[40:43], s7 offen sc1
    buffer_load_dwordx4 v[104:107], v13, s[40:43], s7 offen sc1
    s_waitcnt vmcnt(3)
    v_or_b32 v19, v116, v118
    v_lshl_or_b32 v19, v19, 1, v112
    v_bitop3_b32 v18, v108, v19, 2 bitop3:0xa8
    v_cmp_ne_u32_e64 vcc, 0, v18
    v_add_f32 v16, v117, v119
    v_add_f32 v17, v116, v118
    v_add_f32 v8, v108, v112
    v_add_f32 v9, v109, v113
    v_add_f32 v10, v110, v114
    v_add_f32 v11, v111, v115
    s_cbranch_vccnz L_gp_157
L_gz_161:
L_gd_158:
    v_permlane32_swap_b32 v16, v17
    v_permlane32_swap_b32 v8, v9
    v_add_f32 v16, v16, v17
    v_permlane32_swap_b32 v10, v11
    v_add_f32 v8, v8, v9
    v_add_f32_dpp v16, v16, v16 row_ror:4 row_mask:0xf bank_mask:0xf
    v_add_f32 v10, v10, v11
    v_mov_b32 v30, 1
    v_add_f32_dpp v16, v16, v16 row_ror:8 row_mask:0xf bank_mask:0xf
    v_mov_b32 v17, v16
    v_permlane16_swap_b32 v8, v10
    ds_write_b32 v31, v30 offset:3608
    v_permlane16_swap_b32 v16, v17
    v_add_f32 v16, v16, v17
    v_add_f32 v8, v8, v10
    v_mul_f32 v16, 0x3b000000, v16
    v_mov_b32 v17, v16
    v_add_f32_dpp v8, v8, v8 row_ror:4 row_mask:0xf bank_mask:0xf
    s_cmp_lg_u32 s7, 0
    v_permlane32_swap_b32 v16, v17
    v_fma_f32 v17, -v16, v16, v17
    v_max_f32_e64 v17, 0, v17
    v_cvt_pk_bf16_f32 v17, 0, v17
    v_cvt_pk_bf16_f32 v16, 0, v16
    v_add_f32 v17, 0x3727c5ac, v17
    v_cvt_pk_bf16_f32 v17, 0, v17
    v_sqrt_f32_e64 v17, v17
    v_add_f32_dpp v8, v8, v8 row_ror:8 row_mask:0xf bank_mask:0xf
    v_cvt_pk_bf16_f32 v17, 0, v17
    v_rcp_f32 v17, v17
    v_fma_f32 v8, -v16, v24, v8
    v_mul_f32 v8, v8, v17
    v_cvt_pk_bf16_f32 v10, 0, v8
    v_mul_f32 v12, s75, v10
    v_exp_f32 v12, v12
    v_mov_b32_dpp v11, v10 quad_perm:[2,3,0,1] row_mask:0xf bank_mask:0xf
    v_add_f32 v12, 1.0, v12
    v_rcp_f32 v12, v12
    s_nop 0
    v_cvt_pk_bf16_f32 v8, 0, v12
    v_mul_f32 v8, v8, v11
    v_mov_b32 v9, v8
    s_nop 1
    v_permlane32_swap_b32 v8, v9
    v_cvt_pk_bf16_f32 v8, v8, v9
    s_nop 0
    v_readlane_b32 s66, v8, 0
    v_readlane_b32 s67, v8, 16
    v_readlane_b32 s68, v8, 1
    v_readlane_b32 s69, v8, 17
    v_dot2_f32_bf16 v14, v32, s66, 0
    v_dot2_f32_bf16 v15, v33, s66, 0
    v_dot2_f32_bf16 v16, v34, s66, 0
    v_dot2_f32_bf16 v17, v35, s66, 0
    v_dot2_f32_bf16 v18, v36, s66, 0
    v_dot2_f32_bf16 v19, v37, s66, 0
    v_dot2_f32_bf16 v20, v38, s66, 0
    v_dot2_f32_bf16 v21, v39, s66, 0
    v_dot2c_f32_bf16 v14, s67, v40
    v_dot2c_f32_bf16 v15, s67, v41
    v_dot2c_f32_bf16 v16, s67, v42
    v_dot2c_f32_bf16 v17, s67, v43
    v_dot2c_f32_bf16 v18, s67, v44
    v_dot2c_f32_bf16 v19, s67, v45
    v_dot2c_f32_bf16 v20, s67, v46
    v_dot2c_f32_bf16 v21, s67, v47
    v_dot2c_f32_bf16 v14, s68, v48
    v_dot2c_f32_bf16 v15, s68, v49
    v_dot2c_f32_bf16 v16, s68, v50
    v_dot2c_f32_bf16 v17, s68, v51
    v_dot2c_f32_bf16 v18, s68, v52
    v_dot2c_f32_bf16 v19, s68, v53
    v_dot2c_f32_bf16 v20, s68, v54
    v_dot2c_f32_bf16 v21, s68, v55
    v_dot2c_f32_bf16 v14, s69, v56
    v_dot2c_f32_bf16 v15, s69, v57
    v_dot2c_f32_bf16 v16, s69, v58
    v_dot2c_f32_bf16 v17, s69, v59
    v_dot2c_f32_bf16 v18, s69, v60
    v_dot2c_f32_bf16 v19, s69, v61
    v_dot2c_f32_bf16 v20, s69, v62
    v_dot2c_f32_bf16 v21, s69, v63
    v_and_or_b32 v14, v14, -16, 12
    v_and_or_b32 v18, v18, -16, 12
    s_cbranch_scc1 L_slow_162
    buffer_store_dwordx4 v[14:17], v1, s[40:43], s7 offen
    buffer_store_dwordx4 v[18:21], v1, s[40:43], s7 offen offset:16
L_pub_163:
    s_barrier
    s_barrier
    s_barrier
L_wf_164:
    ds_read_b32 v30, v31 offset:3604
    s_waitcnt lgkmcnt(0)
    v_readfirstlane_b32 s10, v30
    s_nop 0
    s_cmp_ge_u32 s10, 4
    s_cbranch_scc0 L_wfr_165
    s_mov_b32 s65, 0
    s_nop 15
    s_nop 15
    s_nop 15
    s_nop 15
    s_nop 15
    s_nop 15
    s_nop 0
    s_nop 15
    buffer_load_dwordx4 v[96:99], v3, s[40:43], s7 offen sc1
    buffer_load_dwordx4 v[100:103], v4, s[40:43], s7 offen sc1
    buffer_load_dwordx4 v[104:107], v13, s[40:43], s7 offen sc1
    s_nop 15
    s_nop 15
L_gp_166:
    buffer_load_dwordx4 v[108:111], v3, s[40:43], s7 offen sc1
    buffer_load_dwordx4 v[112:115], v4, s[40:43], s7 offen sc1
    buffer_load_dwordx4 v[116:119], v13, s[40:43], s7 offen sc1
    s_add_u32 s65, s65, 1
    s_cmp_lt_u32 s65, s3
    s_cbranch_scc0 L_gz_170
    s_waitcnt vmcnt(3)
    v_or_b32_e64 v19, v104, v106
    v_lshl_or_b32 v19, v19, 2, v100
    v_bitop3_b32 v18, v96, v19, 8 bitop3:0xa8
    v_cmp_ne_u32 vcc, 0, v18
    v_add_f32 v16, v105, v107
    v_add_f32 v17, v104, v106
    v_add_f32 v8, v96, v100
    v_add_f32 v9, v97, v101
    v_add_f32 v10, v98, v102
    v_add_f32 v11, v99, v103
    s_cbranch_vccz L_gd_167
    buffer_load_dwordx4 v[96:99], v3, s[40:43], s7 offen sc1
    buffer_load_dwordx4 v[100:103], v4, s[40:43], s7 offen sc1
    buffer_load_dwordx4 v[104:107], v13, s[40:43], s7 offen sc1
    s_waitcnt vmcnt(3)
    v_or_b32 v19, v116, v118
    v_lshl_or_b32 v19, v19, 2, v112
    v_bitop3_b32 v18, v108, v19, 8 bitop3:0xa8
    v_cmp_ne_u32 vcc, 0, v18
    v_add_f32 v16, v117, v119
    v_add_f32 v17, v116, v118
    v_add_f32 v8, v108, v112
    v_add_f32 v9, v109, v113
    v_add_f32 v10, v110, v114
    v_add_f32 v11, v111, v115
    s_cbranch_vccnz L_gp_166
L_gz_170:
L_gd_167:
    v_permlane32_swap_b32 v16, v17
    v_permlane32_swap_b32 v8, v9
    v_add_f32 v16, v16, v17
    v_permlane32_swap_b32 v10, v11
    v_add_f32_e64 v8, v8, v9
    v_add_f32_dpp v16, v16, v16 row_ror:4 row_mask:0xf bank_mask:0xf
    v_add_f32 v10, v10, v11
    v_mov_b32 v30, 2
    v_add_f32_dpp v16, v16, v16 row_ror:8 row_mask:0xf bank_mask:0xf
    v_mov_b32 v17, v16
    v_permlane16_swap_b32 v8, v10
    ds_write_b32 v31, v30 offset:3608
    v_permlane16_swap_b32 v16, v17
    v_add_f32 v16, v16, v17
    v_add_f32 v8, v8, v10
    v_mul_f32 v16, 0x3b000000, v16
    v_mov_b32 v17, v16
    v_add_f32_dpp v8, v8, v8 row_ror:4 row_mask:0xf bank_mask:0xf
    s_cmp_lg_u32 s7, 0
    v_permlane32_swap_b32 v16, v17
    v_fma_f32 v17, -v16, v16, v17
    v_max_f32_e64 v17, 0, v17
    v_cvt_pk_bf16_f32 v17, 0, v17
    v_cvt_pk_bf16_f32 v16, 0, v16
    v_add_f32 v17, 0x3727c5ac, v17
    v_cvt_pk_bf16_f32 v17, 0, v17
    v_sqrt_f32_e64 v17, v17
    v_add_f32_dpp v8, v8, v8 row_ror:8 row_mask:0xf bank_mask:0xf
    v_cvt_pk_bf16_f32 v17, 0, v17
    v_rcp_f32 v17, v17
    v_fma_f32 v8, -v16, v24, v8
    v_mul_f32 v8, v8, v17
    v_cvt_pk_bf16_f32 v10, 0, v8
    v_mul_f32 v12, s75, v10
    v_exp_f32 v12, v12
    v_mov_b32_dpp v11, v10 quad_perm:[2,3,0,1] row_mask:0xf bank_mask:0xf
    v_add_f32 v12, 1.0, v12
    v_rcp_f32 v12, v12
    s_nop 0
    v_cvt_pk_bf16_f32 v8, 0, v12
    v_mul_f32 v8, v8, v11
    v_mov_b32 v9, v8
    s_nop 1
    v_permlane32_swap_b32 v8, v9
    v_cvt_pk_bf16_f32 v8, v8, v9
    s_nop 0
    v_readlane_b32 s66, v8, 0
    v_readlane_b32 s67, v8, 16
    v_readlane_b32 s68, v8, 1
    v_readlane_b32 s69, v8, 17
    v_dot2_f32_bf16 v14, v32, s66, 0
    v_dot2_f32_bf16 v15, v33, s66, 0
    v_dot2_f32_bf16 v16, v34, s66, 0
    v_dot2_f32_bf16 v17, v35, s66, 0
    v_dot2_f32_bf16 v18, v36, s66, 0
    v_dot2_f32_bf16 v19, v37, s66, 0
    v_dot2_f32_bf16 v20, v38, s66, 0
    v_dot2_f32_bf16 v21, v39, s66, 0
    v_dot2c_f32_bf16 v14, s67, v40
    v_dot2c_f32_bf16 v15, s67, v41
    v_dot2c_f32_bf16 v16, s67, v42
    v_dot2c_f32_bf16 v17, s67, v43
    v_dot2c_f32_bf16 v18, s67, v44
    v_dot2c_f32_bf16 v19, s67, v45
    v_dot2c_f32_bf16 v20, s67, v46
    v_dot2c_f32_bf16 v21, s67, v47
    v_dot2c_f32_bf16 v14, s68, v48
    v_dot2c_f32_bf16 v15, s68, v49
    v_dot2c_f32_bf16 v16, s68, v50
    v_dot2c_f32_bf16 v17, s68, v51
    v_dot2c_f32_bf16 v18, s68, v52
    v_dot2c_f32_bf16 v19, s68, v53
    v_dot2c_f32_bf16 v20, s68, v54
    v_dot2c_f32_bf16 v21, s68, v55
    v_dot2c_f32_bf16 v14, s69, v56
    v_dot2c_f32_bf16 v15, s69, v57
    v_dot2c_f32_bf16 v16, s69, v58
    v_dot2c_f32_bf16 v17, s69, v59
    v_dot2c_f32_bf16 v18, s69, v60
    v_dot2c_f32_bf16 v19, s69, v61
    v_dot2c_f32_bf16 v20, s69, v62
    v_dot2c_f32_bf16 v21, s69, v63
    v_and_b32_e64 v14, -16, v14
    v_and_b32 v18, -16, v18
    s_cbranch_scc1 L_slow_171
    buffer_store_dwordx4 v[14:17], v1, s[40:43], s7 offen
    buffer_store_dwordx4 v[18:21], v1, s[40:43], s7 offen offset:16
L_pub_172:
L_noffn_144:
L_end:
    s_endpgm
L_wfr_146:
    s_nop 4
    s_sleep 1
    s_branch L_wf_145
L_wfr_149:
    s_nop 4
    s_sleep 1
    s_branch L_wf_148
L_wfr_151:
    s_nop 4
    s_sleep 1
    s_branch L_wf_150
L_wfr_156:
    s_nop 4
    s_sleep 1
    s_branch L_wf_155
L_slow_162:
    s_nop 4
    buffer_store_dwordx4 v[14:17], v1, s[40:43], s7 offen sc1
    buffer_store_dwordx4 v[18:21], v1, s[40:43], s7 offen offset:16 sc1
    s_branch L_pub_163
L_wfr_165:
    s_nop 4
    s_sleep 1
    s_branch L_wf_164
    s_nop 0
L_slow_171:
    s_nop 4
    buffer_store_dwordx4 v[14:17], v1, s[40:43], s7 offen sc1
    buffer_store_dwordx4 v[18:21], v1, s[40:43], s7 offen offset:16 sc1
    s_branch L_pub_172
L_fallback:
    s_waitcnt vmcnt(0) lgkmcnt(0)
    s_barrier
    s_and_b32 s6, s2, 7
    s_mov_b32 s7, 0x1000000
    s_mov_b32 s3, 0x40000
    s_mov_b64 exec, -1
    s_branch L_restart
L_code_end:
.section .rodata,"a"
.p2align 6
.amdhsa_kernel interleave_layers__sliding_block_cached__glu_gated_glu__decode_kernel
  .amdhsa_next_free_vgpr 256
  .amdhsa_next_free_sgpr 102
  .amdhsa_accum_offset 256
  .amdhsa_group_segment_fixed_size 0
  .amdhsa_kernarg_size 96
  .amdhsa_user_sgpr_count 2
  .amdhsa_user_sgpr_kernarg_segment_ptr 1
  .amdhsa_system_sgpr_workgroup_id_x 1
.end_amdhsa_kernel
```
